```python
import torch

def _softmax(x, axis=-1):
    return torch.softmax(x, dim=axis)
def _gelu(x):
    return torch.nn.functional.gelu(x, approximate="tanh")
def _silu(x):
    return torch.nn.functional.silu(x)
def _sigmoid(x):
    return torch.sigmoid(x)
def _layernorm(x, axis=-1, eps=1e-5):
    m = x.mean(dim=axis, keepdim=True)
    v = x.var(dim=axis, keepdim=True, unbiased=False)
    return (x - m) / torch.sqrt(v + eps)
def _scatter_add(tgt, idx, src, axis=0):
    return tgt.clone().index_add_(axis, idx, src)
def _segment_sum(src, seg, n):
    out = torch.zeros((n,) + src.shape[1:], dtype=src.dtype)
    return out.index_add_(0, seg, src)
def _pad(x, pw):
    flat = tuple(v for pair in reversed(pw) for v in pair)
    return torch.nn.functional.pad(x, flat)

kernel_name = 'standalone__edge_featured_mpnn_mpnn__graph'

def setup_inputs():

    _w = (lambda a: (lambda t: t.to(torch.bfloat16) if t.is_floating_point() else t)(torch.as_tensor(a)))
    N, deg, D, De = 10000, 16, 256, max(0, 1)
    E = N * deg
    H = 2 * D
    return {
        "x": _w((lambda *s: torch.randn(*s, dtype=torch.bfloat16) * 0.05)(N, D)),
        "e_attr": _w((lambda *s: torch.randn(*s, dtype=torch.bfloat16) * 1.6)(E, De)),
        "src": _w((lambda lo, hi, *s: torch.randint(lo, hi, s))(0, N, E).to(torch.int64)),
        "dst": _w((lambda lo, hi, *s: torch.randint(lo, hi, s))(0, N, E).to(torch.int64)),
        "w1": _w((lambda *s: torch.randn(*s, dtype=torch.bfloat16) * 1.6)(2 * D + De, H) * (1.0 / (2 * D + De) ** 0.5)),
        "b1": _w((lambda *s: torch.randn(*s, dtype=torch.bfloat16) * 0.8)(H) * 0.01),
        "w2": _w((lambda *s: torch.randn(*s, dtype=torch.bfloat16) * 0.05)(H, D) * (1.0 / H ** 0.5)),
        "b2": _w((lambda *s: torch.randn(*s, dtype=torch.bfloat16) * 0.05)(D) * 0.01),
    }

def reference(x, e_attr, src, dst, w1, b1, w2, b2):
    N, D = x.shape
    h_src = x[src]
    h_dst = x[dst]
    m_in = torch.concatenate([h_src, h_dst, e_attr], axis=-1)
    h = _silu(m_in @ w1 + b1)
    msg = h @ w2 + b2
    return _segment_sum(msg, dst, N)
```

```asm
; @launch kernel=k1_kernel grid=(256,1,1) block=(512,1,1) lds=163840
; @launch kernel=k2_kernel grid=(256,1,1) block=(1024,1,1) lds=159744
.amdgcn_target "amdgcn-amd-amdhsa--gfx950"
.text
.globl k1_kernel
.p2align 8
.type k1_kernel,@function
k1_kernel:
    s_cmp_ge_u32 s2, 256
    s_cbranch_scc1 K1_END
    s_getpc_b64 s[22:23]
K1_PC:
    s_sub_u32 s22, s22, K1_PC-k1_kernel
    s_subb_u32 s23, s23, 0
    s_lshr_b32 s3, s2, 3
    s_sub_u32 s3, s3, 5
    s_lshl_b32 s3, s3, 12
    v_lshlrev_b32 v2, 4, v0
    v_add_u32 v2, s3, v2
    v_cmp_gt_u32 vcc, 256, v0
    s_nop 1
    v_cndmask_b32 v2, v2, -1, vcc
    v_cmp_gt_u32 vcc, K2_END-k1_kernel-16, v2
    s_and_saveexec_b64 s[4:5], vcc
    s_cbranch_execz K1_PCX
    global_load_dwordx4 v[228:231], v2, s[22:23]
K1_PCX:
    s_mov_b64 exec, -1
    s_load_dwordx16 s[4:19], s[0:1], 0
    s_load_dwordx2 s[20:21], s[0:1], 80
    s_load_dwordx2 s[52:53], s[0:1], 72
    v_lshrrev_b32 v2, 6, v0
    v_and_b32 v1, 63, v0
    v_readfirstlane_b32 s56, v2
    s_lshr_b32 s68, s2, 3
    s_cmp_lt_u32 s68, 4
    s_cbranch_scc1 K1_SORT
    s_cmp_ge_u32 s56, 4
    s_cbranch_scc1 K1_END
    s_sub_u32 s68, s68, 4
    s_and_b32 s58, s68, 3
    s_lshl_b32 s58, s58, 2
    s_lshr_b32 s68, s68, 2
    s_lshl_b32 s59, s68, 3
    s_and_b32 s57, s2, 7
    s_add_u32 s57, s57, s59
    s_add_u32 s58, s58, s56
    s_cmp_ge_u32 s57, 53
    s_cbranch_scc1 K1_PREP
    s_mul_i32 s67, s56, 40960
    s_add_u32 s61, s67, 8192
    s_mov_b32 s64, 3216550459
    s_mov_b32 s65, 3216550459
    s_lshl_b32 s68, s68, 2
    v_lshrrev_b32 v2, 5, v1
    s_lshl_b32 s59, s56, 3
    v_add_u32 v2, s59, v2
    v_and_b32 v3, 31, v1
    v_add_u32 v4, 0, v2
    v_and_b32 v16, 15, v4
    v_xor_b32 v16, v16, v3
    v_add_u32 v16, s68, v16
    v_and_b32 v16, 31, v16
    v_lshlrev_b32 v16, 4, v16
    v_lshl_add_u32 v16, v2, 9, v16
    v_add_u32 v4, 2, v2
    v_and_b32 v17, 15, v4
    v_xor_b32 v17, v17, v3
    v_add_u32 v17, s68, v17
    v_and_b32 v17, 31, v17
    v_lshlrev_b32 v17, 4, v17
    v_lshl_add_u32 v17, v2, 9, v17
    v_add_u32 v4, 4, v2
    v_and_b32 v18, 15, v4
    v_xor_b32 v18, v18, v3
    v_add_u32 v18, s68, v18
    v_and_b32 v18, 31, v18
    v_lshlrev_b32 v18, 4, v18
    v_lshl_add_u32 v18, v2, 9, v18
    v_add_u32 v4, 6, v2
    v_and_b32 v19, 15, v4
    v_xor_b32 v19, v19, v3
    v_add_u32 v19, s68, v19
    v_and_b32 v19, 31, v19
    v_lshlrev_b32 v19, 4, v19
    v_lshl_add_u32 v19, v2, 9, v19
    s_mul_i32 s62, s57, 98304
    s_mov_b32 s40, 0
    s_add_u32 s41, s40, 1
    s_cmp_eq_u32 s41, 6
    s_cselect_b32 s41, 0, s41
    s_add_u32 s42, s41, 1
    s_cmp_eq_u32 s42, 6
    s_cselect_b32 s42, 0, s42
    s_add_u32 s43, s42, 1
    s_cmp_eq_u32 s43, 6
    s_cselect_b32 s43, 0, s43
    s_add_u32 s44, s43, 1
    s_cmp_eq_u32 s44, 6
    s_cselect_b32 s44, 0, s44
    s_add_u32 s45, s44, 1
    s_cmp_eq_u32 s45, 6
    s_cselect_b32 s45, 0, s45
    v_lshrrev_b32 v2, 3, v1
    v_and_b32 v3, 7, v1
    v_and_b32 v4, 16, v1
    v_lshrrev_b32 v4, 2, v4
    v_xor_b32 v3, v3, v4
    v_lshlrev_b32 v3, 4, v3
    v_lshl_add_u32 v20, v2, 10, v3
    v_add_u32 v232, 7168, v20
    v_add_u32 v233, 14336, v20
    v_add_u32 v234, 21504, v20
    s_lshr_b32 s59, s58, 3
    s_lshl_b32 s59, s59, 18
    s_and_b32 s66, s58, 7
    s_lshl_b32 s66, s66, 7
    s_add_u32 s69, s59, s66
    s_lshl_b32 s70, s68, 13
    v_and_b32 v2, 31, v1
    v_lshrrev_b32 v3, 3, v2
    v_mul_u32_u24 v6, 40960, v3
    v_and_b32 v3, 7, v2
    v_lshl_add_u32 v6, v3, 9, v6
    v_lshrrev_b32 v3, 5, v1
    v_and_b32 v4, 15, v1
    v_xor_b32 v4, v4, v3
    v_lshl_add_u32 v6, v4, 4, v6
    v_xor_b32 v7, 32, v6
    v_xor_b32 v8, 64, v6
    v_xor_b32 v9, 96, v6
    v_xor_b32 v10, 128, v6
    v_xor_b32 v11, 160, v6
    v_xor_b32 v12, 192, v6
    v_xor_b32 v13, 224, v6
    v_lshlrev_b32 v21, 9, v3
    v_lshl_add_u32 v21, v2, 2, v21
    v_lshlrev_b32 v14, 10, v3
    v_bfe_u32 v4, v1, 2, 2
    v_lshl_add_u32 v14, v4, 7, v14
    v_bfe_u32 v4, v1, 3, 1
    v_lshl_add_u32 v14, v4, 6, v14
    v_bfe_u32 v4, v1, 4, 1
    v_lshl_add_u32 v14, v4, 5, v14
    v_and_b32 v4, 3, v1
    v_lshl_add_u32 v14, v4, 3, v14
    v_add_u32 v14, s61, v14
    v_xor_b32 v15, 64, v14
    v_lshlrev_b32 v2, 1, v2
    s_mul_i32 s63, s58, 1302528
    s_mul_i32 s59, s57, 24576
    s_add_u32 s63, s63, s59
    s_waitcnt lgkmcnt(0)
    s_mov_b32 s24, s4
    s_and_b32 s25, s5, 0xffff
    s_mov_b32 s26, 5120000
    s_mov_b32 s27, 0x20000
    s_mov_b32 s28, s12
    s_and_b32 s29, s13, 0xffff
    s_mov_b32 s30, 525312
    s_mov_b32 s31, 0x20000
    s_add_u32 m0, s67, 0
    s_lshl_b32 s59, s40, 14
    s_add_u32 s59, s59, s62
    buffer_load_dwordx4 v16, s[24:27], s59 offen offset:0 lds
    buffer_load_dwordx4 v17, s[24:27], s59 offen offset:1024 lds
    buffer_load_dwordx4 v18, s[24:27], s59 offen offset:2048 lds
    buffer_load_dwordx4 v19, s[24:27], s59 offen offset:3072 lds
    s_add_u32 m0, s61, 0
    s_add_u32 s71, s69, s70
    buffer_load_dwordx4 v20, s[28:31], s71 offen offset:0 lds
    buffer_load_dwordx4 v232, s[28:31], s71 offen offset:1024 lds
    buffer_load_dwordx4 v233, s[28:31], s71 offen offset:2048 lds
    buffer_load_dwordx4 v234, s[28:31], s71 offen offset:3072 lds
    s_add_u32 s70, s70, 32768
    s_and_b32 s70, s70, 0x3ffff
    s_add_u32 m0, s61, 4096
    s_add_u32 s71, s69, s70
    buffer_load_dwordx4 v20, s[28:31], s71 offen offset:0 lds
    buffer_load_dwordx4 v232, s[28:31], s71 offen offset:1024 lds
    buffer_load_dwordx4 v233, s[28:31], s71 offen offset:2048 lds
    buffer_load_dwordx4 v234, s[28:31], s71 offen offset:3072 lds
    s_add_u32 s70, s70, 32768
    s_and_b32 s70, s70, 0x3ffff
    s_add_u32 m0, s61, 8192
    s_add_u32 s71, s69, s70
    buffer_load_dwordx4 v20, s[28:31], s71 offen offset:0 lds
    buffer_load_dwordx4 v232, s[28:31], s71 offen offset:1024 lds
    buffer_load_dwordx4 v233, s[28:31], s71 offen offset:2048 lds
    buffer_load_dwordx4 v234, s[28:31], s71 offen offset:3072 lds
    s_add_u32 s70, s70, 32768
    s_and_b32 s70, s70, 0x3ffff
    s_lshr_b32 s59, s58, 2
    s_mul_i32 s59, s59, 24576
    s_mul_i32 s60, s56, 6144
    s_add_u32 s59, s59, s60
    s_add_u32 s59, s59, s62
    v_lshlrev_b32 v3, 7, v1
    s_mov_b32 exec_hi, 65535
    buffer_load_dword v4, v3, s[24:27], s59 offen
    s_mov_b32 exec_hi, -1
    s_mov_b32 s32, s20
    s_and_b32 s33, s21, 0xffff
    s_mov_b32 s34, 20840448
    s_mov_b32 s35, 0x20000
    s_mov_b32 s36, s14
    s_and_b32 s37, s15, 0xffff
    s_mov_b32 s38, 1024
    s_mov_b32 s39, 0x20000
    s_cmp_ge_u32 s58, 8
    s_cselect_b32 s38, s38, 0
    s_waitcnt vmcnt(13)
    s_barrier
    s_waitcnt vmcnt(11)
    ds_read_b64_tr_b16 v[104:105], v14 offset:0
    ds_read_b64_tr_b16 v[106:107], v14 offset:512
    ds_read_b64_tr_b16 v[108:109], v15 offset:0
    ds_read_b64_tr_b16 v[110:111], v15 offset:512
    ds_read_b128 v[24:27], v6 offset:0
    s_waitcnt vmcnt(9)
    ds_read_b64_tr_b16 v[112:113], v14 offset:2048
    ds_read_b64_tr_b16 v[114:115], v14 offset:2560
    ds_read_b64_tr_b16 v[116:117], v15 offset:2048
    ds_read_b64_tr_b16 v[118:119], v15 offset:2560
    ds_read_b128 v[28:31], v7 offset:0
    s_waitcnt vmcnt(7)
    ds_read_b64_tr_b16 v[120:121], v14 offset:4096
    ds_read_b64_tr_b16 v[122:123], v14 offset:4608
    ds_read_b64_tr_b16 v[124:125], v15 offset:4096
    ds_read_b64_tr_b16 v[126:127], v15 offset:4608
    ds_read_b128 v[32:35], v8 offset:0
    s_waitcnt lgkmcnt(10)
    v_mfma_f32_32x32x16_bf16 v[40:55], v[24:27], v[104:107], 0
    s_add_u32 m0, s61, 12288
    s_add_u32 s71, s69, s70
    buffer_load_dwordx4 v20, s[28:31], s71 offen offset:0 lds
    buffer_load_dwordx4 v232, s[28:31], s71 offen offset:1024 lds
    v_mfma_f32_32x32x16_bf16 v[56:71], v[24:27], v[108:111], 0
    s_waitcnt vmcnt(7)
    ds_read_b64_tr_b16 v[128:129], v14 offset:6144
    ds_read_b64_tr_b16 v[130:131], v14 offset:6656
    ds_read_b64_tr_b16 v[132:133], v15 offset:6144
    ds_read_b64_tr_b16 v[134:135], v15 offset:6656
    ds_read_b128 v[36:39], v9 offset:0
    s_waitcnt lgkmcnt(10)
    v_mfma_f32_32x32x16_bf16 v[40:55], v[28:31], v[112:115], v[40:55]
    buffer_load_dwordx4 v233, s[28:31], s71 offen offset:2048 lds
    buffer_load_dwordx4 v234, s[28:31], s71 offen offset:3072 lds
    s_add_u32 s70, s70, 32768
    s_and_b32 s70, s70, 0x3ffff
    v_mfma_f32_32x32x16_bf16 v[56:71], v[28:31], v[116:119], v[56:71]
    s_waitcnt vmcnt(7)
    ds_read_b64_tr_b16 v[136:137], v14 offset:8192
    ds_read_b64_tr_b16 v[138:139], v14 offset:8704
    ds_read_b64_tr_b16 v[140:141], v15 offset:8192
    ds_read_b64_tr_b16 v[142:143], v15 offset:8704
    ds_read_b128 v[24:27], v10 offset:0
    s_waitcnt lgkmcnt(10)
    v_mfma_f32_32x32x16_bf16 v[40:55], v[32:35], v[120:123], v[40:55]
    s_add_u32 m0, s61, 16384
    s_add_u32 s71, s69, s70
    buffer_load_dwordx4 v20, s[28:31], s71 offen offset:0 lds
    buffer_load_dwordx4 v232, s[28:31], s71 offen offset:1024 lds
    v_mfma_f32_32x32x16_bf16 v[56:71], v[32:35], v[124:127], v[56:71]
    s_waitcnt vmcnt(7)
    ds_read_b64_tr_b16 v[144:145], v14 offset:10240
    ds_read_b64_tr_b16 v[146:147], v14 offset:10752
    ds_read_b64_tr_b16 v[148:149], v15 offset:10240
    ds_read_b64_tr_b16 v[150:151], v15 offset:10752
    ds_read_b128 v[28:31], v11 offset:0
    s_waitcnt lgkmcnt(10)
    v_mfma_f32_32x32x16_bf16 v[40:55], v[36:39], v[128:131], v[40:55]
    buffer_load_dwordx4 v233, s[28:31], s71 offen offset:2048 lds
    buffer_load_dwordx4 v234, s[28:31], s71 offen offset:3072 lds
    s_add_u32 s70, s70, 32768
    s_and_b32 s70, s70, 0x3ffff
    v_mfma_f32_32x32x16_bf16 v[56:71], v[36:39], v[132:135], v[56:71]
    s_waitcnt vmcnt(6)
    ds_read_b64_tr_b16 v[152:153], v14 offset:12288
    ds_read_b64_tr_b16 v[154:155], v14 offset:12800
    ds_read_b64_tr_b16 v[156:157], v15 offset:12288
    ds_read_b64_tr_b16 v[158:159], v15 offset:12800
    ds_read_b128 v[32:35], v12 offset:0
    s_waitcnt lgkmcnt(10)
    v_mfma_f32_32x32x16_bf16 v[40:55], v[24:27], v[136:139], v[40:55]
    s_add_u32 m0, s61, 20480
    s_add_u32 s71, s69, s70
    buffer_load_dwordx4 v20, s[28:31], s71 offen offset:0 lds
    buffer_load_dwordx4 v232, s[28:31], s71 offen offset:1024 lds
    v_mfma_f32_32x32x16_bf16 v[56:71], v[24:27], v[140:143], v[56:71]
    s_waitcnt vmcnt(6)
    ds_read_b64_tr_b16 v[160:161], v14 offset:14336
    ds_read_b64_tr_b16 v[162:163], v14 offset:14848
    ds_read_b64_tr_b16 v[164:165], v15 offset:14336
    ds_read_b64_tr_b16 v[166:167], v15 offset:14848
    ds_read_b128 v[36:39], v13 offset:0
    s_waitcnt lgkmcnt(10)
    v_mfma_f32_32x32x16_bf16 v[40:55], v[28:31], v[144:147], v[40:55]
    buffer_load_dwordx4 v233, s[28:31], s71 offen offset:2048 lds
    buffer_load_dwordx4 v234, s[28:31], s71 offen offset:3072 lds
    s_add_u32 s70, s70, 32768
    s_and_b32 s70, s70, 0x3ffff
    v_mfma_f32_32x32x16_bf16 v[56:71], v[28:31], v[148:151], v[56:71]
    s_waitcnt vmcnt(6)
    ds_read_b64_tr_b16 v[168:169], v14 offset:16384
    ds_read_b64_tr_b16 v[170:171], v14 offset:16896
    ds_read_b64_tr_b16 v[172:173], v15 offset:16384
    ds_read_b64_tr_b16 v[174:175], v15 offset:16896
    ds_read_b128 v[24:27], v6 offset:256
    s_waitcnt lgkmcnt(10)
    v_mfma_f32_32x32x16_bf16 v[40:55], v[32:35], v[152:155], v[40:55]
    s_add_u32 m0, s61, 24576
    s_add_u32 s71, s69, s70
    buffer_load_dwordx4 v20, s[28:31], s71 offen offset:0 lds
    buffer_load_dwordx4 v232, s[28:31], s71 offen offset:1024 lds
    v_mfma_f32_32x32x16_bf16 v[56:71], v[32:35], v[156:159], v[56:71]
    s_waitcnt vmcnt(6)
    ds_read_b64_tr_b16 v[176:177], v14 offset:18432
    ds_read_b64_tr_b16 v[178:179], v14 offset:18944
    ds_read_b64_tr_b16 v[180:181], v15 offset:18432
    ds_read_b64_tr_b16 v[182:183], v15 offset:18944
    ds_read_b128 v[28:31], v7 offset:256
    s_waitcnt lgkmcnt(10)
    v_mfma_f32_32x32x16_bf16 v[40:55], v[36:39], v[160:163], v[40:55]
    buffer_load_dwordx4 v233, s[28:31], s71 offen offset:2048 lds
    buffer_load_dwordx4 v234, s[28:31], s71 offen offset:3072 lds
    s_add_u32 s70, s70, 32768
    s_and_b32 s70, s70, 0x3ffff
    v_mfma_f32_32x32x16_bf16 v[56:71], v[36:39], v[164:167], v[56:71]
    s_waitcnt vmcnt(6)
    ds_read_b64_tr_b16 v[184:185], v14 offset:20480
    ds_read_b64_tr_b16 v[186:187], v14 offset:20992
    ds_read_b64_tr_b16 v[188:189], v15 offset:20480
    ds_read_b64_tr_b16 v[190:191], v15 offset:20992
    ds_read_b128 v[32:35], v8 offset:256
    s_waitcnt lgkmcnt(10)
    v_mfma_f32_32x32x16_bf16 v[40:55], v[24:27], v[168:171], v[40:55]
    s_add_u32 m0, s61, 28672
    s_add_u32 s71, s69, s70
    buffer_load_dwordx4 v20, s[28:31], s71 offen offset:0 lds
    buffer_load_dwordx4 v232, s[28:31], s71 offen offset:1024 lds
    v_mfma_f32_32x32x16_bf16 v[56:71], v[24:27], v[172:175], v[56:71]
    s_waitcnt vmcnt(6)
    ds_read_b64_tr_b16 v[192:193], v14 offset:22528
    ds_read_b64_tr_b16 v[194:195], v14 offset:23040
    ds_read_b64_tr_b16 v[196:197], v15 offset:22528
    ds_read_b64_tr_b16 v[198:199], v15 offset:23040
    ds_read_b128 v[36:39], v9 offset:256
    s_waitcnt lgkmcnt(10)
    v_mfma_f32_32x32x16_bf16 v[40:55], v[28:31], v[176:179], v[40:55]
    buffer_load_dwordx4 v233, s[28:31], s71 offen offset:2048 lds
    buffer_load_dwordx4 v234, s[28:31], s71 offen offset:3072 lds
    s_add_u32 s70, s70, 32768
    s_and_b32 s70, s70, 0x3ffff
    v_mfma_f32_32x32x16_bf16 v[56:71], v[28:31], v[180:183], v[56:71]
    s_waitcnt vmcnt(6)
    ds_read_b64_tr_b16 v[200:201], v14 offset:24576
    ds_read_b64_tr_b16 v[202:203], v14 offset:25088
    ds_read_b64_tr_b16 v[204:205], v15 offset:24576
    ds_read_b64_tr_b16 v[206:207], v15 offset:25088
    ds_read_b128 v[24:27], v10 offset:256
    s_waitcnt lgkmcnt(10)
    v_mfma_f32_32x32x16_bf16 v[40:55], v[32:35], v[184:187], v[40:55]
    s_add_u32 m0, s67, 4096
    s_lshl_b32 s59, s41, 14
    s_add_u32 s59, s59, s62
    buffer_load_dwordx4 v16, s[24:27], s59 offen offset:0 lds
    buffer_load_dwordx4 v17, s[24:27], s59 offen offset:1024 lds
    buffer_load_dwordx4 v18, s[24:27], s59 offen offset:2048 lds
    buffer_load_dwordx4 v19, s[24:27], s59 offen offset:3072 lds
    buffer_load_ushort v22, v2, s[36:39], s66 offen
    buffer_load_ushort v23, v2, s[36:39], s66 offen offset:64
    v_mfma_f32_32x32x16_bf16 v[56:71], v[32:35], v[188:191], v[56:71]
    s_waitcnt vmcnt(10)
    ds_read_b64_tr_b16 v[208:209], v14 offset:26624
    ds_read_b64_tr_b16 v[210:211], v14 offset:27136
    ds_read_b64_tr_b16 v[212:213], v15 offset:26624
    ds_read_b64_tr_b16 v[214:215], v15 offset:27136
    ds_read_b128 v[28:31], v11 offset:256
    s_waitcnt lgkmcnt(10)
    v_mfma_f32_32x32x16_bf16 v[40:55], v[36:39], v[192:195], v[40:55]
    s_add_u32 m0, s67, 8192
    s_lshl_b32 s59, s42, 14
    s_add_u32 s59, s59, s62
    buffer_load_dwordx4 v16, s[24:27], s59 offen offset:0 lds
    buffer_load_dwordx4 v17, s[24:27], s59 offen offset:1024 lds
    buffer_load_dwordx4 v18, s[24:27], s59 offen offset:2048 lds
    buffer_load_dwordx4 v19, s[24:27], s59 offen offset:3072 lds
    v_mfma_f32_32x32x16_bf16 v[56:71], v[36:39], v[196:199], v[56:71]
    s_waitcnt vmcnt(12)
    ds_read_b64_tr_b16 v[216:217], v14 offset:28672
    ds_read_b64_tr_b16 v[218:219], v14 offset:29184
    ds_read_b64_tr_b16 v[220:221], v15 offset:28672
    ds_read_b64_tr_b16 v[222:223], v15 offset:29184
    ds_read_b128 v[32:35], v12 offset:256
    s_waitcnt lgkmcnt(10)
    v_mfma_f32_32x32x16_bf16 v[40:55], v[24:27], v[200:203], v[40:55]
    v_mfma_f32_32x32x16_bf16 v[56:71], v[24:27], v[204:207], v[56:71]
    s_waitcnt vmcnt(10)
    ds_read_b64_tr_b16 v[224:225], v14 offset:30720
    ds_read_b64_tr_b16 v[226:227], v14 offset:31232
    ds_read_b64_tr_b16 v[228:229], v15 offset:30720
    ds_read_b64_tr_b16 v[230:231], v15 offset:31232
    ds_read_b128 v[36:39], v13 offset:256
    s_waitcnt lgkmcnt(10)
    v_mfma_f32_32x32x16_bf16 v[40:55], v[28:31], v[208:211], v[40:55]
    v_mfma_f32_32x32x16_bf16 v[56:71], v[28:31], v[212:215], v[56:71]
    s_waitcnt lgkmcnt(5)
    v_mfma_f32_32x32x16_bf16 v[40:55], v[32:35], v[216:219], v[40:55]
    v_mfma_f32_32x32x16_bf16 v[56:71], v[32:35], v[220:223], v[56:71]
    s_waitcnt lgkmcnt(0)
    v_mfma_f32_32x32x16_bf16 v[40:55], v[36:39], v[224:227], v[40:55]
    v_mfma_f32_32x32x16_bf16 v[56:71], v[36:39], v[228:231], v[56:71]
    s_waitcnt vmcnt(4)
    s_barrier
    ds_read_b128 v[24:27], v6 offset:4096
    ds_read_b128 v[28:31], v7 offset:4096
    ds_read_b128 v[32:35], v8 offset:4096
    v_lshlrev_b32 v22, 16, v22
    v_lshlrev_b32 v23, 16, v23
    v_mul_f32 v22, s64, v22
    v_mul_f32 v23, s64, v23
    s_waitcnt lgkmcnt(2)
    v_mfma_f32_32x32x16_bf16 v[72:87], v[24:27], v[104:107], 0
    s_add_u32 m0, s67, 12288
    s_lshl_b32 s59, s43, 14
    s_add_u32 s59, s59, s62
    buffer_load_dwordx4 v16, s[24:27], s59 offen offset:0 lds
    buffer_load_dwordx4 v17, s[24:27], s59 offen offset:1024 lds
    buffer_load_dwordx4 v18, s[24:27], s59 offen offset:2048 lds
    buffer_load_dwordx4 v19, s[24:27], s59 offen offset:3072 lds
    ds_read_b128 v[36:39], v9 offset:4096
    v_mfma_f32_32x32x16_bf16 v[88:103], v[24:27], v[108:111], 0
    s_waitcnt lgkmcnt(2)
    v_mfma_f32_32x32x16_bf16 v[72:87], v[28:31], v[112:115], v[72:87]
    s_add_u32 m0, s67, 16384
    s_lshl_b32 s59, s44, 14
    s_add_u32 s59, s59, s62
    buffer_load_dwordx4 v16, s[24:27], s59 offen offset:0 lds
    buffer_load_dwordx4 v17, s[24:27], s59 offen offset:1024 lds
    buffer_load_dwordx4 v18, s[24:27], s59 offen offset:2048 lds
    buffer_load_dwordx4 v19, s[24:27], s59 offen offset:3072 lds
    ds_read_b128 v[24:27], v10 offset:4096
    v_mfma_f32_32x32x16_bf16 v[88:103], v[28:31], v[116:119], v[88:103]
    s_waitcnt lgkmcnt(2)
    v_mfma_f32_32x32x16_bf16 v[72:87], v[32:35], v[120:123], v[72:87]
    s_add_u32 m0, s67, 20480
    s_lshl_b32 s59, s45, 14
    s_add_u32 s59, s59, s62
    buffer_load_dwordx4 v16, s[24:27], s59 offen offset:0 lds
    buffer_load_dwordx4 v17, s[24:27], s59 offen offset:1024 lds
    buffer_load_dwordx4 v18, s[24:27], s59 offen offset:2048 lds
    buffer_load_dwordx4 v19, s[24:27], s59 offen offset:3072 lds
    ds_read_b128 v[28:31], v11 offset:4096
    v_mfma_f32_32x32x16_bf16 v[88:103], v[32:35], v[124:127], v[88:103]
    s_waitcnt lgkmcnt(2)
    v_mfma_f32_32x32x16_bf16 v[72:87], v[36:39], v[128:131], v[72:87]
    ds_read_b128 v[32:35], v12 offset:4096
    s_lshl_b32 s60, s40, 12
    s_add_u32 s60, s60, s63
    v_fma_f32 v40, v40, s64, v22
    v_mfma_f32_32x32x16_bf16 v[88:103], v[36:39], v[132:135], v[88:103]
    v_fma_f32 v56, v56, s64, v23
    v_fma_f32 v41, v41, s64, v22
    v_fma_f32 v57, v57, s64, v23
    s_waitcnt lgkmcnt(2)
    v_mfma_f32_32x32x16_bf16 v[72:87], v[24:27], v[136:139], v[72:87]
    ds_read_b128 v[36:39], v13 offset:4096
    v_cvt_pk_bf16_f32 v40, v40, v56
    v_cvt_pk_bf16_f32 v41, v41, v57
    v_mfma_f32_32x32x16_bf16 v[88:103], v[24:27], v[140:143], v[88:103]
    buffer_store_dword v40, v21, s[32:35], s60 offen offset:0 sc1
    buffer_store_dword v41, v21, s[32:35], s60 offen offset:128 sc1
    v_fma_f32 v42, v42, s64, v22
    s_waitcnt lgkmcnt(2)
    v_mfma_f32_32x32x16_bf16 v[72:87], v[28:31], v[144:147], v[72:87]
    ds_read_b128 v[24:27], v6 offset:4352
    v_fma_f32 v58, v58, s64, v23
    v_fma_f32 v43, v43, s64, v22
    v_mfma_f32_32x32x16_bf16 v[88:103], v[28:31], v[148:151], v[88:103]
    v_fma_f32 v59, v59, s64, v23
    v_cvt_pk_bf16_f32 v42, v42, v58
    v_cvt_pk_bf16_f32 v43, v43, v59
    s_waitcnt lgkmcnt(2)
    v_mfma_f32_32x32x16_bf16 v[72:87], v[32:35], v[152:155], v[72:87]
    ds_read_b128 v[28:31], v7 offset:4352
    buffer_store_dword v42, v21, s[32:35], s60 offen offset:256 sc1
    buffer_store_dword v43, v21, s[32:35], s60 offen offset:384 sc1
    v_mfma_f32_32x32x16_bf16 v[88:103], v[32:35], v[156:159], v[88:103]
    v_fma_f32 v44, v44, s64, v22
    v_fma_f32 v60, v60, s64, v23
    v_fma_f32 v45, v45, s64, v22
    s_waitcnt lgkmcnt(2)
    v_mfma_f32_32x32x16_bf16 v[72:87], v[36:39], v[160:163], v[72:87]
    ds_read_b128 v[32:35], v8 offset:4352
    v_fma_f32 v61, v61, s64, v23
    v_cvt_pk_bf16_f32 v44, v44, v60
    v_mfma_f32_32x32x16_bf16 v[88:103], v[36:39], v[164:167], v[88:103]
    v_cvt_pk_bf16_f32 v45, v45, v61
    buffer_store_dword v44, v21, s[32:35], s60 offen offset:1024 sc1
    buffer_store_dword v45, v21, s[32:35], s60 offen offset:1152 sc1
    s_waitcnt lgkmcnt(2)
    v_mfma_f32_32x32x16_bf16 v[72:87], v[24:27], v[168:171], v[72:87]
    ds_read_b128 v[36:39], v9 offset:4352
    v_fma_f32 v46, v46, s64, v22
    v_fma_f32 v62, v62, s64, v23
    v_mfma_f32_32x32x16_bf16 v[88:103], v[24:27], v[172:175], v[88:103]
    v_fma_f32 v47, v47, s64, v22
    v_fma_f32 v63, v63, s64, v23
    v_cvt_pk_bf16_f32 v46, v46, v62
    s_waitcnt lgkmcnt(2)
    v_mfma_f32_32x32x16_bf16 v[72:87], v[28:31], v[176:179], v[72:87]
    ds_read_b128 v[24:27], v10 offset:4352
    v_cvt_pk_bf16_f32 v47, v47, v63
    buffer_store_dword v46, v21, s[32:35], s60 offen offset:1280 sc1
    v_mfma_f32_32x32x16_bf16 v[88:103], v[28:31], v[180:183], v[88:103]
    buffer_store_dword v47, v21, s[32:35], s60 offen offset:1408 sc1
    v_fma_f32 v48, v48, s64, v22
    v_fma_f32 v64, v64, s64, v23
    s_waitcnt lgkmcnt(2)
    v_mfma_f32_32x32x16_bf16 v[72:87], v[32:35], v[184:187], v[72:87]
    ds_read_b128 v[28:31], v11 offset:4352
    v_fma_f32 v49, v49, s64, v22
    v_fma_f32 v65, v65, s64, v23
    v_mfma_f32_32x32x16_bf16 v[88:103], v[32:35], v[188:191], v[88:103]
    v_cvt_pk_bf16_f32 v48, v48, v64
    v_cvt_pk_bf16_f32 v49, v49, v65
    buffer_store_dword v48, v21, s[32:35], s60 offen offset:2048 sc1
    s_waitcnt lgkmcnt(2)
    v_mfma_f32_32x32x16_bf16 v[72:87], v[36:39], v[192:195], v[72:87]
    ds_read_b128 v[32:35], v12 offset:4352
    buffer_store_dword v49, v21, s[32:35], s60 offen offset:2176 sc1
    v_fma_f32 v50, v50, s64, v22
    v_mfma_f32_32x32x16_bf16 v[88:103], v[36:39], v[196:199], v[88:103]
    v_fma_f32 v66, v66, s64, v23
    v_fma_f32 v51, v51, s64, v22
    v_fma_f32 v67, v67, s64, v23
    s_waitcnt lgkmcnt(2)
    v_mfma_f32_32x32x16_bf16 v[72:87], v[24:27], v[200:203], v[72:87]
    ds_read_b128 v[36:39], v13 offset:4352
    v_cvt_pk_bf16_f32 v50, v50, v66
    v_cvt_pk_bf16_f32 v51, v51, v67
    v_mfma_f32_32x32x16_bf16 v[88:103], v[24:27], v[204:207], v[88:103]
    buffer_store_dword v50, v21, s[32:35], s60 offen offset:2304 sc1
    buffer_store_dword v51, v21, s[32:35], s60 offen offset:2432 sc1
    v_fma_f32 v52, v52, s64, v22
    s_waitcnt vmcnt(12)
    s_barrier
    s_waitcnt lgkmcnt(2)
    v_mfma_f32_32x32x16_bf16 v[72:87], v[28:31], v[208:211], v[72:87]
    ds_read_b128 v[24:27], v6 offset:8192
    v_fma_f32 v68, v68, s64, v23
    v_fma_f32 v53, v53, s64, v22
    v_mfma_f32_32x32x16_bf16 v[88:103], v[28:31], v[212:215], v[88:103]
    v_fma_f32 v69, v69, s64, v23
    v_cvt_pk_bf16_f32 v52, v52, v68
    v_cvt_pk_bf16_f32 v53, v53, v69
    s_waitcnt lgkmcnt(2)
    v_mfma_f32_32x32x16_bf16 v[72:87], v[32:35], v[216:219], v[72:87]
    ds_read_b128 v[28:31], v7 offset:8192
    buffer_store_dword v52, v21, s[32:35], s60 offen offset:3072 sc1
    buffer_store_dword v53, v21, s[32:35], s60 offen offset:3200 sc1
    v_mfma_f32_32x32x16_bf16 v[88:103], v[32:35], v[220:223], v[88:103]
    v_fma_f32 v54, v54, s64, v22
    v_fma_f32 v70, v70, s64, v23
    v_fma_f32 v55, v55, s64, v22
    s_waitcnt lgkmcnt(2)
    v_mfma_f32_32x32x16_bf16 v[72:87], v[36:39], v[224:227], v[72:87]
    ds_read_b128 v[32:35], v8 offset:8192
    v_fma_f32 v71, v71, s64, v23
    v_cvt_pk_bf16_f32 v54, v54, v70
    v_mfma_f32_32x32x16_bf16 v[88:103], v[36:39], v[228:231], v[88:103]
    v_cvt_pk_bf16_f32 v55, v55, v71
    buffer_store_dword v54, v21, s[32:35], s60 offen offset:3328 sc1
    buffer_store_dword v55, v21, s[32:35], s60 offen offset:3456 sc1
    s_waitcnt lgkmcnt(2)
    v_mfma_f32_32x32x16_bf16 v[40:55], v[24:27], v[104:107], 0
    ds_read_b128 v[36:39], v9 offset:8192
    v_mfma_f32_32x32x16_bf16 v[56:71], v[24:27], v[108:111], 0
    s_waitcnt lgkmcnt(2)
    v_mfma_f32_32x32x16_bf16 v[40:55], v[28:31], v[112:115], v[40:55]
    ds_read_b128 v[24:27], v10 offset:8192
    v_mfma_f32_32x32x16_bf16 v[56:71], v[28:31], v[116:119], v[56:71]
    s_waitcnt lgkmcnt(2)
    v_mfma_f32_32x32x16_bf16 v[40:55], v[32:35], v[120:123], v[40:55]
    ds_read_b128 v[28:31], v11 offset:8192
    v_mfma_f32_32x32x16_bf16 v[56:71], v[32:35], v[124:127], v[56:71]
    s_waitcnt lgkmcnt(2)
    v_mfma_f32_32x32x16_bf16 v[40:55], v[36:39], v[128:131], v[40:55]
    ds_read_b128 v[32:35], v12 offset:8192
    s_lshl_b32 s60, s41, 12
    s_add_u32 s60, s60, s63
    v_fma_f32 v72, v72, s64, v22
    v_mfma_f32_32x32x16_bf16 v[56:71], v[36:39], v[132:135], v[56:71]
    v_fma_f32 v88, v88, s64, v23
    v_fma_f32 v73, v73, s64, v22
    v_fma_f32 v89, v89, s64, v23
    s_waitcnt lgkmcnt(2)
    v_mfma_f32_32x32x16_bf16 v[40:55], v[24:27], v[136:139], v[40:55]
    ds_read_b128 v[36:39], v13 offset:8192
    v_cvt_pk_bf16_f32 v72, v72, v88
    v_cvt_pk_bf16_f32 v73, v73, v89
    v_mfma_f32_32x32x16_bf16 v[56:71], v[24:27], v[140:143], v[56:71]
    buffer_store_dword v72, v21, s[32:35], s60 offen offset:0 sc1
    buffer_store_dword v73, v21, s[32:35], s60 offen offset:128 sc1
    v_fma_f32 v74, v74, s64, v22
    s_waitcnt lgkmcnt(2)
    v_mfma_f32_32x32x16_bf16 v[40:55], v[28:31], v[144:147], v[40:55]
    ds_read_b128 v[24:27], v6 offset:8448
    v_fma_f32 v90, v90, s64, v23
    v_fma_f32 v75, v75, s64, v22
    v_mfma_f32_32x32x16_bf16 v[56:71], v[28:31], v[148:151], v[56:71]
    v_fma_f32 v91, v91, s64, v23
    v_cvt_pk_bf16_f32 v74, v74, v90
    v_cvt_pk_bf16_f32 v75, v75, v91
    s_waitcnt lgkmcnt(2)
    v_mfma_f32_32x32x16_bf16 v[40:55], v[32:35], v[152:155], v[40:55]
    ds_read_b128 v[28:31], v7 offset:8448
    buffer_store_dword v74, v21, s[32:35], s60 offen offset:256 sc1
    buffer_store_dword v75, v21, s[32:35], s60 offen offset:384 sc1
    v_mfma_f32_32x32x16_bf16 v[56:71], v[32:35], v[156:159], v[56:71]
    v_fma_f32 v76, v76, s64, v22
    v_fma_f32 v92, v92, s64, v23
    v_fma_f32 v77, v77, s64, v22
    s_waitcnt lgkmcnt(2)
    v_mfma_f32_32x32x16_bf16 v[40:55], v[36:39], v[160:163], v[40:55]
    ds_read_b128 v[32:35], v8 offset:8448
    v_fma_f32 v93, v93, s64, v23
    v_cvt_pk_bf16_f32 v76, v76, v92
    v_mfma_f32_32x32x16_bf16 v[56:71], v[36:39], v[164:167], v[56:71]
    v_cvt_pk_bf16_f32 v77, v77, v93
    buffer_store_dword v76, v21, s[32:35], s60 offen offset:1024 sc1
    buffer_store_dword v77, v21, s[32:35], s60 offen offset:1152 sc1
    s_waitcnt lgkmcnt(2)
    v_mfma_f32_32x32x16_bf16 v[40:55], v[24:27], v[168:171], v[40:55]
    ds_read_b128 v[36:39], v9 offset:8448
    v_fma_f32 v78, v78, s64, v22
    v_fma_f32 v94, v94, s64, v23
    v_mfma_f32_32x32x16_bf16 v[56:71], v[24:27], v[172:175], v[56:71]
    v_fma_f32 v79, v79, s64, v22
    v_fma_f32 v95, v95, s64, v23
    v_cvt_pk_bf16_f32 v78, v78, v94
    s_waitcnt lgkmcnt(2)
    v_mfma_f32_32x32x16_bf16 v[40:55], v[28:31], v[176:179], v[40:55]
    ds_read_b128 v[24:27], v10 offset:8448
    v_cvt_pk_bf16_f32 v79, v79, v95
    buffer_store_dword v78, v21, s[32:35], s60 offen offset:1280 sc1
    v_mfma_f32_32x32x16_bf16 v[56:71], v[28:31], v[180:183], v[56:71]
    buffer_store_dword v79, v21, s[32:35], s60 offen offset:1408 sc1
    v_fma_f32 v80, v80, s64, v22
    v_fma_f32 v96, v96, s64, v23
    s_waitcnt lgkmcnt(2)
    v_mfma_f32_32x32x16_bf16 v[40:55], v[32:35], v[184:187], v[40:55]
    ds_read_b128 v[28:31], v11 offset:8448
    v_fma_f32 v81, v81, s64, v22
    v_fma_f32 v97, v97, s64, v23
    v_mfma_f32_32x32x16_bf16 v[56:71], v[32:35], v[188:191], v[56:71]
    v_cvt_pk_bf16_f32 v80, v80, v96
    v_cvt_pk_bf16_f32 v81, v81, v97
    buffer_store_dword v80, v21, s[32:35], s60 offen offset:2048 sc1
    s_waitcnt lgkmcnt(2)
    v_mfma_f32_32x32x16_bf16 v[40:55], v[36:39], v[192:195], v[40:55]
    ds_read_b128 v[32:35], v12 offset:8448
    buffer_store_dword v81, v21, s[32:35], s60 offen offset:2176 sc1
    v_fma_f32 v82, v82, s64, v22
    v_mfma_f32_32x32x16_bf16 v[56:71], v[36:39], v[196:199], v[56:71]
    v_fma_f32 v98, v98, s64, v23
    v_fma_f32 v83, v83, s64, v22
    v_fma_f32 v99, v99, s64, v23
    s_waitcnt lgkmcnt(2)
    v_mfma_f32_32x32x16_bf16 v[40:55], v[24:27], v[200:203], v[40:55]
    ds_read_b128 v[36:39], v13 offset:8448
    v_cvt_pk_bf16_f32 v82, v82, v98
    v_cvt_pk_bf16_f32 v83, v83, v99
    v_mfma_f32_32x32x16_bf16 v[56:71], v[24:27], v[204:207], v[56:71]
    buffer_store_dword v82, v21, s[32:35], s60 offen offset:2304 sc1
    buffer_store_dword v83, v21, s[32:35], s60 offen offset:2432 sc1
    v_fma_f32 v84, v84, s64, v22
    s_waitcnt lgkmcnt(2)
    v_mfma_f32_32x32x16_bf16 v[40:55], v[28:31], v[208:211], v[40:55]
    ds_read_b128 v[24:27], v6 offset:12288
    v_fma_f32 v100, v100, s64, v23
    v_fma_f32 v85, v85, s64, v22
    v_mfma_f32_32x32x16_bf16 v[56:71], v[28:31], v[212:215], v[56:71]
    v_fma_f32 v101, v101, s64, v23
    v_cvt_pk_bf16_f32 v84, v84, v100
    v_cvt_pk_bf16_f32 v85, v85, v101
    s_waitcnt lgkmcnt(2)
    v_mfma_f32_32x32x16_bf16 v[40:55], v[32:35], v[216:219], v[40:55]
    ds_read_b128 v[28:31], v7 offset:12288
    buffer_store_dword v84, v21, s[32:35], s60 offen offset:3072 sc1
    buffer_store_dword v85, v21, s[32:35], s60 offen offset:3200 sc1
    v_mfma_f32_32x32x16_bf16 v[56:71], v[32:35], v[220:223], v[56:71]
    v_fma_f32 v86, v86, s64, v22
    v_fma_f32 v102, v102, s64, v23
    v_fma_f32 v87, v87, s64, v22
    s_waitcnt lgkmcnt(2)
    v_mfma_f32_32x32x16_bf16 v[40:55], v[36:39], v[224:227], v[40:55]
    ds_read_b128 v[32:35], v8 offset:12288
    v_fma_f32 v103, v103, s64, v23
    v_cvt_pk_bf16_f32 v86, v86, v102
    v_mfma_f32_32x32x16_bf16 v[56:71], v[36:39], v[228:231], v[56:71]
    v_cvt_pk_bf16_f32 v87, v87, v103
    buffer_store_dword v86, v21, s[32:35], s60 offen offset:3328 sc1
    buffer_store_dword v87, v21, s[32:35], s60 offen offset:3456 sc1
    s_waitcnt lgkmcnt(2)
    v_mfma_f32_32x32x16_bf16 v[72:87], v[24:27], v[104:107], 0
    ds_read_b128 v[36:39], v9 offset:12288
    v_mfma_f32_32x32x16_bf16 v[88:103], v[24:27], v[108:111], 0
    s_waitcnt lgkmcnt(2)
    v_mfma_f32_32x32x16_bf16 v[72:87], v[28:31], v[112:115], v[72:87]
    ds_read_b128 v[24:27], v10 offset:12288
    v_mfma_f32_32x32x16_bf16 v[88:103], v[28:31], v[116:119], v[88:103]
    s_waitcnt lgkmcnt(2)
    v_mfma_f32_32x32x16_bf16 v[72:87], v[32:35], v[120:123], v[72:87]
    ds_read_b128 v[28:31], v11 offset:12288
    v_mfma_f32_32x32x16_bf16 v[88:103], v[32:35], v[124:127], v[88:103]
    s_waitcnt lgkmcnt(2)
    v_mfma_f32_32x32x16_bf16 v[72:87], v[36:39], v[128:131], v[72:87]
    ds_read_b128 v[32:35], v12 offset:12288
    s_lshl_b32 s60, s42, 12
    s_add_u32 s60, s60, s63
    v_fma_f32 v40, v40, s64, v22
    v_mfma_f32_32x32x16_bf16 v[88:103], v[36:39], v[132:135], v[88:103]
    v_fma_f32 v56, v56, s64, v23
    v_fma_f32 v41, v41, s64, v22
    v_fma_f32 v57, v57, s64, v23
    s_waitcnt lgkmcnt(2)
    v_mfma_f32_32x32x16_bf16 v[72:87], v[24:27], v[136:139], v[72:87]
    ds_read_b128 v[36:39], v13 offset:12288
    v_cvt_pk_bf16_f32 v40, v40, v56
    v_cvt_pk_bf16_f32 v41, v41, v57
    v_mfma_f32_32x32x16_bf16 v[88:103], v[24:27], v[140:143], v[88:103]
    buffer_store_dword v40, v21, s[32:35], s60 offen offset:0 sc1
    buffer_store_dword v41, v21, s[32:35], s60 offen offset:128 sc1
    v_fma_f32 v42, v42, s64, v22
    s_waitcnt lgkmcnt(2)
    v_mfma_f32_32x32x16_bf16 v[72:87], v[28:31], v[144:147], v[72:87]
    ds_read_b128 v[24:27], v6 offset:12544
    v_fma_f32 v58, v58, s64, v23
    v_fma_f32 v43, v43, s64, v22
    v_mfma_f32_32x32x16_bf16 v[88:103], v[28:31], v[148:151], v[88:103]
    v_fma_f32 v59, v59, s64, v23
    v_cvt_pk_bf16_f32 v42, v42, v58
    v_cvt_pk_bf16_f32 v43, v43, v59
    s_waitcnt lgkmcnt(2)
    v_mfma_f32_32x32x16_bf16 v[72:87], v[32:35], v[152:155], v[72:87]
    ds_read_b128 v[28:31], v7 offset:12544
    buffer_store_dword v42, v21, s[32:35], s60 offen offset:256 sc1
    buffer_store_dword v43, v21, s[32:35], s60 offen offset:384 sc1
    v_mfma_f32_32x32x16_bf16 v[88:103], v[32:35], v[156:159], v[88:103]
    v_fma_f32 v44, v44, s64, v22
    v_fma_f32 v60, v60, s64, v23
    v_fma_f32 v45, v45, s64, v22
    s_waitcnt lgkmcnt(2)
    v_mfma_f32_32x32x16_bf16 v[72:87], v[36:39], v[160:163], v[72:87]
    ds_read_b128 v[32:35], v8 offset:12544
    v_fma_f32 v61, v61, s64, v23
    v_cvt_pk_bf16_f32 v44, v44, v60
    v_mfma_f32_32x32x16_bf16 v[88:103], v[36:39], v[164:167], v[88:103]
    v_cvt_pk_bf16_f32 v45, v45, v61
    buffer_store_dword v44, v21, s[32:35], s60 offen offset:1024 sc1
    buffer_store_dword v45, v21, s[32:35], s60 offen offset:1152 sc1
    s_waitcnt lgkmcnt(2)
    v_mfma_f32_32x32x16_bf16 v[72:87], v[24:27], v[168:171], v[72:87]
    ds_read_b128 v[36:39], v9 offset:12544
    v_fma_f32 v46, v46, s64, v22
    v_fma_f32 v62, v62, s64, v23
    v_mfma_f32_32x32x16_bf16 v[88:103], v[24:27], v[172:175], v[88:103]
    v_fma_f32 v47, v47, s64, v22
    v_fma_f32 v63, v63, s64, v23
    v_cvt_pk_bf16_f32 v46, v46, v62
    s_waitcnt lgkmcnt(2)
    v_mfma_f32_32x32x16_bf16 v[72:87], v[28:31], v[176:179], v[72:87]
    ds_read_b128 v[24:27], v10 offset:12544
    v_cvt_pk_bf16_f32 v47, v47, v63
    buffer_store_dword v46, v21, s[32:35], s60 offen offset:1280 sc1
    v_mfma_f32_32x32x16_bf16 v[88:103], v[28:31], v[180:183], v[88:103]
    buffer_store_dword v47, v21, s[32:35], s60 offen offset:1408 sc1
    v_fma_f32 v48, v48, s64, v22
    v_fma_f32 v64, v64, s64, v23
    s_waitcnt lgkmcnt(2)
    v_mfma_f32_32x32x16_bf16 v[72:87], v[32:35], v[184:187], v[72:87]
    ds_read_b128 v[28:31], v11 offset:12544
    v_fma_f32 v49, v49, s64, v22
    v_fma_f32 v65, v65, s64, v23
    v_mfma_f32_32x32x16_bf16 v[88:103], v[32:35], v[188:191], v[88:103]
    v_cvt_pk_bf16_f32 v48, v48, v64
    v_cvt_pk_bf16_f32 v49, v49, v65
    buffer_store_dword v48, v21, s[32:35], s60 offen offset:2048 sc1
    s_waitcnt lgkmcnt(2)
    v_mfma_f32_32x32x16_bf16 v[72:87], v[36:39], v[192:195], v[72:87]
    ds_read_b128 v[32:35], v12 offset:12544
    buffer_store_dword v49, v21, s[32:35], s60 offen offset:2176 sc1
    v_fma_f32 v50, v50, s64, v22
    v_mfma_f32_32x32x16_bf16 v[88:103], v[36:39], v[196:199], v[88:103]
    v_fma_f32 v66, v66, s64, v23
    v_fma_f32 v51, v51, s64, v22
    v_fma_f32 v67, v67, s64, v23
    s_waitcnt lgkmcnt(2)
    v_mfma_f32_32x32x16_bf16 v[72:87], v[24:27], v[200:203], v[72:87]
    ds_read_b128 v[36:39], v13 offset:12544
    v_cvt_pk_bf16_f32 v50, v50, v66
    v_cvt_pk_bf16_f32 v51, v51, v67
    v_mfma_f32_32x32x16_bf16 v[88:103], v[24:27], v[204:207], v[88:103]
    buffer_store_dword v50, v21, s[32:35], s60 offen offset:2304 sc1
    buffer_store_dword v51, v21, s[32:35], s60 offen offset:2432 sc1
    v_fma_f32 v52, v52, s64, v22
    s_waitcnt lgkmcnt(2)
    v_mfma_f32_32x32x16_bf16 v[72:87], v[28:31], v[208:211], v[72:87]
    ds_read_b128 v[24:27], v6 offset:16384
    v_fma_f32 v68, v68, s64, v23
    v_fma_f32 v53, v53, s64, v22
    v_mfma_f32_32x32x16_bf16 v[88:103], v[28:31], v[212:215], v[88:103]
    v_fma_f32 v69, v69, s64, v23
    v_cvt_pk_bf16_f32 v52, v52, v68
    v_cvt_pk_bf16_f32 v53, v53, v69
    s_waitcnt lgkmcnt(2)
    v_mfma_f32_32x32x16_bf16 v[72:87], v[32:35], v[216:219], v[72:87]
    ds_read_b128 v[28:31], v7 offset:16384
    buffer_store_dword v52, v21, s[32:35], s60 offen offset:3072 sc1
    buffer_store_dword v53, v21, s[32:35], s60 offen offset:3200 sc1
    v_mfma_f32_32x32x16_bf16 v[88:103], v[32:35], v[220:223], v[88:103]
    v_fma_f32 v54, v54, s64, v22
    v_fma_f32 v70, v70, s64, v23
    v_fma_f32 v55, v55, s64, v22
    s_waitcnt lgkmcnt(2)
    v_mfma_f32_32x32x16_bf16 v[72:87], v[36:39], v[224:227], v[72:87]
    ds_read_b128 v[32:35], v8 offset:16384
    v_fma_f32 v71, v71, s64, v23
    v_cvt_pk_bf16_f32 v54, v54, v70
    v_mfma_f32_32x32x16_bf16 v[88:103], v[36:39], v[228:231], v[88:103]
    v_cvt_pk_bf16_f32 v55, v55, v71
    buffer_store_dword v54, v21, s[32:35], s60 offen offset:3328 sc1
    buffer_store_dword v55, v21, s[32:35], s60 offen offset:3456 sc1
    s_waitcnt lgkmcnt(2)
    v_mfma_f32_32x32x16_bf16 v[40:55], v[24:27], v[104:107], 0
    ds_read_b128 v[36:39], v9 offset:16384
    v_mfma_f32_32x32x16_bf16 v[56:71], v[24:27], v[108:111], 0
    s_waitcnt lgkmcnt(2)
    v_mfma_f32_32x32x16_bf16 v[40:55], v[28:31], v[112:115], v[40:55]
    ds_read_b128 v[24:27], v10 offset:16384
    v_mfma_f32_32x32x16_bf16 v[56:71], v[28:31], v[116:119], v[56:71]
    s_waitcnt lgkmcnt(2)
    v_mfma_f32_32x32x16_bf16 v[40:55], v[32:35], v[120:123], v[40:55]
    ds_read_b128 v[28:31], v11 offset:16384
    v_mfma_f32_32x32x16_bf16 v[56:71], v[32:35], v[124:127], v[56:71]
    s_waitcnt lgkmcnt(2)
    v_mfma_f32_32x32x16_bf16 v[40:55], v[36:39], v[128:131], v[40:55]
    ds_read_b128 v[32:35], v12 offset:16384
    s_lshl_b32 s60, s43, 12
    s_add_u32 s60, s60, s63
    v_fma_f32 v72, v72, s64, v22
    v_mfma_f32_32x32x16_bf16 v[56:71], v[36:39], v[132:135], v[56:71]
    v_fma_f32 v88, v88, s64, v23
    v_fma_f32 v73, v73, s64, v22
    v_fma_f32 v89, v89, s64, v23
    s_waitcnt lgkmcnt(2)
    v_mfma_f32_32x32x16_bf16 v[40:55], v[24:27], v[136:139], v[40:55]
    ds_read_b128 v[36:39], v13 offset:16384
    v_cvt_pk_bf16_f32 v72, v72, v88
    v_cvt_pk_bf16_f32 v73, v73, v89
    v_mfma_f32_32x32x16_bf16 v[56:71], v[24:27], v[140:143], v[56:71]
    buffer_store_dword v72, v21, s[32:35], s60 offen offset:0 sc1
    buffer_store_dword v73, v21, s[32:35], s60 offen offset:128 sc1
    v_fma_f32 v74, v74, s64, v22
    s_waitcnt lgkmcnt(2)
    v_mfma_f32_32x32x16_bf16 v[40:55], v[28:31], v[144:147], v[40:55]
    ds_read_b128 v[24:27], v6 offset:16640
    v_fma_f32 v90, v90, s64, v23
    v_fma_f32 v75, v75, s64, v22
    v_mfma_f32_32x32x16_bf16 v[56:71], v[28:31], v[148:151], v[56:71]
    v_fma_f32 v91, v91, s64, v23
    v_cvt_pk_bf16_f32 v74, v74, v90
    v_cvt_pk_bf16_f32 v75, v75, v91
    s_waitcnt lgkmcnt(2)
    v_mfma_f32_32x32x16_bf16 v[40:55], v[32:35], v[152:155], v[40:55]
    ds_read_b128 v[28:31], v7 offset:16640
    buffer_store_dword v74, v21, s[32:35], s60 offen offset:256 sc1
    buffer_store_dword v75, v21, s[32:35], s60 offen offset:384 sc1
    v_mfma_f32_32x32x16_bf16 v[56:71], v[32:35], v[156:159], v[56:71]
    v_fma_f32 v76, v76, s64, v22
    v_fma_f32 v92, v92, s64, v23
    v_fma_f32 v77, v77, s64, v22
    s_waitcnt lgkmcnt(2)
    v_mfma_f32_32x32x16_bf16 v[40:55], v[36:39], v[160:163], v[40:55]
    ds_read_b128 v[32:35], v8 offset:16640
    v_fma_f32 v93, v93, s64, v23
    v_cvt_pk_bf16_f32 v76, v76, v92
    v_mfma_f32_32x32x16_bf16 v[56:71], v[36:39], v[164:167], v[56:71]
    v_cvt_pk_bf16_f32 v77, v77, v93
    buffer_store_dword v76, v21, s[32:35], s60 offen offset:1024 sc1
    buffer_store_dword v77, v21, s[32:35], s60 offen offset:1152 sc1
    s_waitcnt lgkmcnt(2)
    v_mfma_f32_32x32x16_bf16 v[40:55], v[24:27], v[168:171], v[40:55]
    ds_read_b128 v[36:39], v9 offset:16640
    v_fma_f32 v78, v78, s64, v22
    v_fma_f32 v94, v94, s64, v23
    v_mfma_f32_32x32x16_bf16 v[56:71], v[24:27], v[172:175], v[56:71]
    v_fma_f32 v79, v79, s64, v22
    v_fma_f32 v95, v95, s64, v23
    v_cvt_pk_bf16_f32 v78, v78, v94
    s_waitcnt lgkmcnt(2)
    v_mfma_f32_32x32x16_bf16 v[40:55], v[28:31], v[176:179], v[40:55]
    ds_read_b128 v[24:27], v10 offset:16640
    v_cvt_pk_bf16_f32 v79, v79, v95
    buffer_store_dword v78, v21, s[32:35], s60 offen offset:1280 sc1
    v_mfma_f32_32x32x16_bf16 v[56:71], v[28:31], v[180:183], v[56:71]
    buffer_store_dword v79, v21, s[32:35], s60 offen offset:1408 sc1
    v_fma_f32 v80, v80, s64, v22
    v_fma_f32 v96, v96, s64, v23
    s_waitcnt lgkmcnt(2)
    v_mfma_f32_32x32x16_bf16 v[40:55], v[32:35], v[184:187], v[40:55]
    ds_read_b128 v[28:31], v11 offset:16640
    v_fma_f32 v81, v81, s64, v22
    v_fma_f32 v97, v97, s64, v23
    v_mfma_f32_32x32x16_bf16 v[56:71], v[32:35], v[188:191], v[56:71]
    v_cvt_pk_bf16_f32 v80, v80, v96
    v_cvt_pk_bf16_f32 v81, v81, v97
    buffer_store_dword v80, v21, s[32:35], s60 offen offset:2048 sc1
    s_waitcnt lgkmcnt(2)
    v_mfma_f32_32x32x16_bf16 v[40:55], v[36:39], v[192:195], v[40:55]
    ds_read_b128 v[32:35], v12 offset:16640
    buffer_store_dword v81, v21, s[32:35], s60 offen offset:2176 sc1
    v_fma_f32 v82, v82, s64, v22
    v_mfma_f32_32x32x16_bf16 v[56:71], v[36:39], v[196:199], v[56:71]
    v_fma_f32 v98, v98, s64, v23
    v_fma_f32 v83, v83, s64, v22
    v_fma_f32 v99, v99, s64, v23
    s_waitcnt lgkmcnt(2)
    v_mfma_f32_32x32x16_bf16 v[40:55], v[24:27], v[200:203], v[40:55]
    ds_read_b128 v[36:39], v13 offset:16640
    v_cvt_pk_bf16_f32 v82, v82, v98
    v_cvt_pk_bf16_f32 v83, v83, v99
    v_mfma_f32_32x32x16_bf16 v[56:71], v[24:27], v[204:207], v[56:71]
    buffer_store_dword v82, v21, s[32:35], s60 offen offset:2304 sc1
    buffer_store_dword v83, v21, s[32:35], s60 offen offset:2432 sc1
    v_fma_f32 v84, v84, s64, v22
    s_waitcnt lgkmcnt(2)
    v_mfma_f32_32x32x16_bf16 v[40:55], v[28:31], v[208:211], v[40:55]
    ds_read_b128 v[24:27], v6 offset:20480
    v_fma_f32 v100, v100, s64, v23
    v_fma_f32 v85, v85, s64, v22
    v_mfma_f32_32x32x16_bf16 v[56:71], v[28:31], v[212:215], v[56:71]
    v_fma_f32 v101, v101, s64, v23
    v_cvt_pk_bf16_f32 v84, v84, v100
    v_cvt_pk_bf16_f32 v85, v85, v101
    s_waitcnt lgkmcnt(2)
    v_mfma_f32_32x32x16_bf16 v[40:55], v[32:35], v[216:219], v[40:55]
    ds_read_b128 v[28:31], v7 offset:20480
    buffer_store_dword v84, v21, s[32:35], s60 offen offset:3072 sc1
    buffer_store_dword v85, v21, s[32:35], s60 offen offset:3200 sc1
    v_mfma_f32_32x32x16_bf16 v[56:71], v[32:35], v[220:223], v[56:71]
    v_fma_f32 v86, v86, s64, v22
    v_fma_f32 v102, v102, s64, v23
    v_fma_f32 v87, v87, s64, v22
    s_waitcnt lgkmcnt(2)
    v_mfma_f32_32x32x16_bf16 v[40:55], v[36:39], v[224:227], v[40:55]
    ds_read_b128 v[32:35], v8 offset:20480
    v_fma_f32 v103, v103, s64, v23
    v_cvt_pk_bf16_f32 v86, v86, v102
    v_mfma_f32_32x32x16_bf16 v[56:71], v[36:39], v[228:231], v[56:71]
    v_cvt_pk_bf16_f32 v87, v87, v103
    buffer_store_dword v86, v21, s[32:35], s60 offen offset:3328 sc1
    buffer_store_dword v87, v21, s[32:35], s60 offen offset:3456 sc1
    s_waitcnt lgkmcnt(2)
    v_mfma_f32_32x32x16_bf16 v[72:87], v[24:27], v[104:107], 0
    ds_read_b128 v[36:39], v9 offset:20480
    v_mfma_f32_32x32x16_bf16 v[88:103], v[24:27], v[108:111], 0
    s_waitcnt lgkmcnt(2)
    v_mfma_f32_32x32x16_bf16 v[72:87], v[28:31], v[112:115], v[72:87]
    ds_read_b128 v[24:27], v10 offset:20480
    v_mfma_f32_32x32x16_bf16 v[88:103], v[28:31], v[116:119], v[88:103]
    s_waitcnt lgkmcnt(2)
    v_mfma_f32_32x32x16_bf16 v[72:87], v[32:35], v[120:123], v[72:87]
    ds_read_b128 v[28:31], v11 offset:20480
    v_mfma_f32_32x32x16_bf16 v[88:103], v[32:35], v[124:127], v[88:103]
    s_waitcnt lgkmcnt(2)
    v_mfma_f32_32x32x16_bf16 v[72:87], v[36:39], v[128:131], v[72:87]
    ds_read_b128 v[32:35], v12 offset:20480
    s_lshl_b32 s60, s44, 12
    s_add_u32 s60, s60, s63
    v_fma_f32 v40, v40, s64, v22
    v_mfma_f32_32x32x16_bf16 v[88:103], v[36:39], v[132:135], v[88:103]
    v_fma_f32 v56, v56, s64, v23
    v_fma_f32 v41, v41, s64, v22
    v_fma_f32 v57, v57, s64, v23
    s_waitcnt lgkmcnt(2)
    v_mfma_f32_32x32x16_bf16 v[72:87], v[24:27], v[136:139], v[72:87]
    ds_read_b128 v[36:39], v13 offset:20480
    v_cvt_pk_bf16_f32 v40, v40, v56
    v_cvt_pk_bf16_f32 v41, v41, v57
    v_mfma_f32_32x32x16_bf16 v[88:103], v[24:27], v[140:143], v[88:103]
    buffer_store_dword v40, v21, s[32:35], s60 offen offset:0 sc1
    buffer_store_dword v41, v21, s[32:35], s60 offen offset:128 sc1
    v_fma_f32 v42, v42, s64, v22
    s_waitcnt lgkmcnt(2)
    v_mfma_f32_32x32x16_bf16 v[72:87], v[28:31], v[144:147], v[72:87]
    ds_read_b128 v[24:27], v6 offset:20736
    v_fma_f32 v58, v58, s64, v23
    v_fma_f32 v43, v43, s64, v22
    v_mfma_f32_32x32x16_bf16 v[88:103], v[28:31], v[148:151], v[88:103]
    v_fma_f32 v59, v59, s64, v23
    v_cvt_pk_bf16_f32 v42, v42, v58
    v_cvt_pk_bf16_f32 v43, v43, v59
    s_waitcnt lgkmcnt(2)
    v_mfma_f32_32x32x16_bf16 v[72:87], v[32:35], v[152:155], v[72:87]
    ds_read_b128 v[28:31], v7 offset:20736
    buffer_store_dword v42, v21, s[32:35], s60 offen offset:256 sc1
    buffer_store_dword v43, v21, s[32:35], s60 offen offset:384 sc1
    v_mfma_f32_32x32x16_bf16 v[88:103], v[32:35], v[156:159], v[88:103]
    v_fma_f32 v44, v44, s64, v22
    v_fma_f32 v60, v60, s64, v23
    v_fma_f32 v45, v45, s64, v22
    s_waitcnt lgkmcnt(2)
    v_mfma_f32_32x32x16_bf16 v[72:87], v[36:39], v[160:163], v[72:87]
    ds_read_b128 v[32:35], v8 offset:20736
    v_fma_f32 v61, v61, s64, v23
    v_cvt_pk_bf16_f32 v44, v44, v60
    v_mfma_f32_32x32x16_bf16 v[88:103], v[36:39], v[164:167], v[88:103]
    v_cvt_pk_bf16_f32 v45, v45, v61
    buffer_store_dword v44, v21, s[32:35], s60 offen offset:1024 sc1
    buffer_store_dword v45, v21, s[32:35], s60 offen offset:1152 sc1
    s_waitcnt lgkmcnt(2)
    v_mfma_f32_32x32x16_bf16 v[72:87], v[24:27], v[168:171], v[72:87]
    ds_read_b128 v[36:39], v9 offset:20736
    v_fma_f32 v46, v46, s64, v22
    v_fma_f32 v62, v62, s64, v23
    v_mfma_f32_32x32x16_bf16 v[88:103], v[24:27], v[172:175], v[88:103]
    v_fma_f32 v47, v47, s64, v22
    v_fma_f32 v63, v63, s64, v23
    v_cvt_pk_bf16_f32 v46, v46, v62
    s_waitcnt lgkmcnt(2)
    v_mfma_f32_32x32x16_bf16 v[72:87], v[28:31], v[176:179], v[72:87]
    ds_read_b128 v[24:27], v10 offset:20736
    v_cvt_pk_bf16_f32 v47, v47, v63
    buffer_store_dword v46, v21, s[32:35], s60 offen offset:1280 sc1
    v_mfma_f32_32x32x16_bf16 v[88:103], v[28:31], v[180:183], v[88:103]
    buffer_store_dword v47, v21, s[32:35], s60 offen offset:1408 sc1
    v_fma_f32 v48, v48, s64, v22
    v_fma_f32 v64, v64, s64, v23
    s_waitcnt lgkmcnt(2)
    v_mfma_f32_32x32x16_bf16 v[72:87], v[32:35], v[184:187], v[72:87]
    ds_read_b128 v[28:31], v11 offset:20736
    v_fma_f32 v49, v49, s64, v22
    v_fma_f32 v65, v65, s64, v23
    v_mfma_f32_32x32x16_bf16 v[88:103], v[32:35], v[188:191], v[88:103]
    v_cvt_pk_bf16_f32 v48, v48, v64
    v_cvt_pk_bf16_f32 v49, v49, v65
    buffer_store_dword v48, v21, s[32:35], s60 offen offset:2048 sc1
    s_waitcnt lgkmcnt(2)
    v_mfma_f32_32x32x16_bf16 v[72:87], v[36:39], v[192:195], v[72:87]
    ds_read_b128 v[32:35], v12 offset:20736
    buffer_store_dword v49, v21, s[32:35], s60 offen offset:2176 sc1
    v_fma_f32 v50, v50, s64, v22
    v_mfma_f32_32x32x16_bf16 v[88:103], v[36:39], v[196:199], v[88:103]
    v_fma_f32 v66, v66, s64, v23
    v_fma_f32 v51, v51, s64, v22
    v_fma_f32 v67, v67, s64, v23
    s_waitcnt lgkmcnt(2)
    v_mfma_f32_32x32x16_bf16 v[72:87], v[24:27], v[200:203], v[72:87]
    ds_read_b128 v[36:39], v13 offset:20736
    v_cvt_pk_bf16_f32 v50, v50, v66
    v_cvt_pk_bf16_f32 v51, v51, v67
    v_mfma_f32_32x32x16_bf16 v[88:103], v[24:27], v[204:207], v[88:103]
    buffer_store_dword v50, v21, s[32:35], s60 offen offset:2304 sc1
    buffer_store_dword v51, v21, s[32:35], s60 offen offset:2432 sc1
    v_fma_f32 v52, v52, s64, v22
    s_waitcnt lgkmcnt(2)
    v_mfma_f32_32x32x16_bf16 v[72:87], v[28:31], v[208:211], v[72:87]
    v_fma_f32 v68, v68, s64, v23
    v_fma_f32 v53, v53, s64, v22
    v_mfma_f32_32x32x16_bf16 v[88:103], v[28:31], v[212:215], v[88:103]
    v_fma_f32 v69, v69, s64, v23
    v_cvt_pk_bf16_f32 v52, v52, v68
    v_cvt_pk_bf16_f32 v53, v53, v69
    s_waitcnt lgkmcnt(1)
    v_mfma_f32_32x32x16_bf16 v[72:87], v[32:35], v[216:219], v[72:87]
    buffer_store_dword v52, v21, s[32:35], s60 offen offset:3072 sc1
    buffer_store_dword v53, v21, s[32:35], s60 offen offset:3200 sc1
    v_mfma_f32_32x32x16_bf16 v[88:103], v[32:35], v[220:223], v[88:103]
    v_fma_f32 v54, v54, s64, v22
    v_fma_f32 v70, v70, s64, v23
    v_fma_f32 v55, v55, s64, v22
    s_waitcnt lgkmcnt(0)
    v_mfma_f32_32x32x16_bf16 v[72:87], v[36:39], v[224:227], v[72:87]
    v_fma_f32 v71, v71, s64, v23
    v_cvt_pk_bf16_f32 v54, v54, v70
    v_mfma_f32_32x32x16_bf16 v[88:103], v[36:39], v[228:231], v[88:103]
    v_cvt_pk_bf16_f32 v55, v55, v71
    buffer_store_dword v54, v21, s[32:35], s60 offen offset:3328 sc1
    buffer_store_dword v55, v21, s[32:35], s60 offen offset:3456 sc1
    s_nop 15
    s_lshl_b32 s60, s45, 12
    s_add_u32 s60, s60, s63
    v_fma_f32 v72, v72, s64, v22
    v_fma_f32 v88, v88, s64, v23
    v_fma_f32 v73, v73, s64, v22
    v_fma_f32 v89, v89, s64, v23
    v_cvt_pk_bf16_f32 v72, v72, v88
    v_cvt_pk_bf16_f32 v73, v73, v89
    buffer_store_dword v72, v21, s[32:35], s60 offen offset:0 sc1
    buffer_store_dword v73, v21, s[32:35], s60 offen offset:128 sc1
    v_fma_f32 v74, v74, s64, v22
    v_fma_f32 v90, v90, s64, v23
    v_fma_f32 v75, v75, s64, v22
    v_fma_f32 v91, v91, s64, v23
    v_cvt_pk_bf16_f32 v74, v74, v90
    v_cvt_pk_bf16_f32 v75, v75, v91
    buffer_store_dword v74, v21, s[32:35], s60 offen offset:256 sc1
    buffer_store_dword v75, v21, s[32:35], s60 offen offset:384 sc1
    v_fma_f32 v76, v76, s64, v22
    v_fma_f32 v92, v92, s64, v23
    v_fma_f32 v77, v77, s64, v22
    v_fma_f32 v93, v93, s64, v23
    v_cvt_pk_bf16_f32 v76, v76, v92
    v_cvt_pk_bf16_f32 v77, v77, v93
    buffer_store_dword v76, v21, s[32:35], s60 offen offset:1024 sc1
    buffer_store_dword v77, v21, s[32:35], s60 offen offset:1152 sc1
    v_fma_f32 v78, v78, s64, v22
    v_fma_f32 v94, v94, s64, v23
    v_fma_f32 v79, v79, s64, v22
    v_fma_f32 v95, v95, s64, v23
    v_cvt_pk_bf16_f32 v78, v78, v94
    v_cvt_pk_bf16_f32 v79, v79, v95
    buffer_store_dword v78, v21, s[32:35], s60 offen offset:1280 sc1
    buffer_store_dword v79, v21, s[32:35], s60 offen offset:1408 sc1
    v_fma_f32 v80, v80, s64, v22
    v_fma_f32 v96, v96, s64, v23
    v_fma_f32 v81, v81, s64, v22
    v_fma_f32 v97, v97, s64, v23
    v_cvt_pk_bf16_f32 v80, v80, v96
    v_cvt_pk_bf16_f32 v81, v81, v97
    buffer_store_dword v80, v21, s[32:35], s60 offen offset:2048 sc1
    buffer_store_dword v81, v21, s[32:35], s60 offen offset:2176 sc1
    v_fma_f32 v82, v82, s64, v22
    v_fma_f32 v98, v98, s64, v23
    v_fma_f32 v83, v83, s64, v22
    v_fma_f32 v99, v99, s64, v23
    v_cvt_pk_bf16_f32 v82, v82, v98
    v_cvt_pk_bf16_f32 v83, v83, v99
    buffer_store_dword v82, v21, s[32:35], s60 offen offset:2304 sc1
    buffer_store_dword v83, v21, s[32:35], s60 offen offset:2432 sc1
    v_fma_f32 v84, v84, s64, v22
    v_fma_f32 v100, v100, s64, v23
    v_fma_f32 v85, v85, s64, v22
    v_fma_f32 v101, v101, s64, v23
    v_cvt_pk_bf16_f32 v84, v84, v100
    v_cvt_pk_bf16_f32 v85, v85, v101
    buffer_store_dword v84, v21, s[32:35], s60 offen offset:3072 sc1
    buffer_store_dword v85, v21, s[32:35], s60 offen offset:3200 sc1
    v_fma_f32 v86, v86, s64, v22
    v_fma_f32 v102, v102, s64, v23
    v_fma_f32 v87, v87, s64, v22
    v_fma_f32 v103, v103, s64, v23
    v_cvt_pk_bf16_f32 v86, v86, v102
    v_cvt_pk_bf16_f32 v87, v87, v103
    buffer_store_dword v86, v21, s[32:35], s60 offen offset:3328 sc1
    buffer_store_dword v87, v21, s[32:35], s60 offen offset:3456 sc1
    s_endpgm
K1_PREP:
    s_cmp_ge_u32 s57, 55
    s_cbranch_scc1 K1_CPREP
    s_sub_u32 s59, s57, 53
    s_lshl_b32 s59, s59, 4
    s_add_u32 s58, s58, s59
    v_and_b32 v2, 15, v1
    v_lshrrev_b32 v3, 4, v1
    v_lshlrev_b32 v2, 2, v2
    v_lshl_add_u32 v20, v3, 11, v2
    v_lshlrev_b32 v21, 4, v1
    s_lshr_b32 s59, s58, 2
    s_lshl_b32 s59, s59, 6
    s_and_b32 s60, s58, 3
    s_lshl_b32 s60, s60, 16
    s_add_u32 s62, s59, s60
    s_lshl_b32 s63, s58, 13
    s_waitcnt lgkmcnt(0)
    s_mov_b32 s24, s16
    s_and_b32 s25, s17, 0xffff
    s_mov_b32 s26, 262144
    s_mov_b32 s27, 0x20000
    s_add_u32 s28, s20, 33718272
    s_addc_u32 s29, s21, 0
    s_and_b32 s29, s29, 0xffff
    s_mov_b32 s30, 262144
    s_mov_b32 s31, 0x20000
    s_add_u32 s59, s62, 0
    buffer_load_dword v104, v20, s[24:27], s59 offen
    s_add_u32 s59, s62, 16384
    buffer_load_dword v105, v20, s[24:27], s59 offen
    s_add_u32 s59, s62, 512
    buffer_load_dword v106, v20, s[24:27], s59 offen
    s_add_u32 s59, s62, 16896
    buffer_load_dword v107, v20, s[24:27], s59 offen
    s_add_u32 s59, s62, 1024
    buffer_load_dword v108, v20, s[24:27], s59 offen
    s_add_u32 s59, s62, 17408
    buffer_load_dword v109, v20, s[24:27], s59 offen
    s_add_u32 s59, s62, 1536
    buffer_load_dword v110, v20, s[24:27], s59 offen
    s_add_u32 s59, s62, 17920
    buffer_load_dword v111, v20, s[24:27], s59 offen
    s_add_u32 s59, s62, 8192
    buffer_load_dword v112, v20, s[24:27], s59 offen
    s_add_u32 s59, s62, 24576
    buffer_load_dword v113, v20, s[24:27], s59 offen
    s_add_u32 s59, s62, 8704
    buffer_load_dword v114, v20, s[24:27], s59 offen
    s_add_u32 s59, s62, 25088
    buffer_load_dword v115, v20, s[24:27], s59 offen
    s_add_u32 s59, s62, 9216
    buffer_load_dword v116, v20, s[24:27], s59 offen
    s_add_u32 s59, s62, 25600
    buffer_load_dword v117, v20, s[24:27], s59 offen
    s_add_u32 s59, s62, 9728
    buffer_load_dword v118, v20, s[24:27], s59 offen
    s_add_u32 s59, s62, 26112
    buffer_load_dword v119, v20, s[24:27], s59 offen
    s_add_u32 s59, s62, 32768
    buffer_load_dword v120, v20, s[24:27], s59 offen
    s_add_u32 s59, s62, 49152
    buffer_load_dword v121, v20, s[24:27], s59 offen
    s_add_u32 s59, s62, 33280
    buffer_load_dword v122, v20, s[24:27], s59 offen
    s_add_u32 s59, s62, 49664
    buffer_load_dword v123, v20, s[24:27], s59 offen
    s_add_u32 s59, s62, 33792
    buffer_load_dword v124, v20, s[24:27], s59 offen
    s_add_u32 s59, s62, 50176
    buffer_load_dword v125, v20, s[24:27], s59 offen
    s_add_u32 s59, s62, 34304
    buffer_load_dword v126, v20, s[24:27], s59 offen
    s_add_u32 s59, s62, 50688
    buffer_load_dword v127, v20, s[24:27], s59 offen
    s_add_u32 s59, s62, 40960
    buffer_load_dword v128, v20, s[24:27], s59 offen
    s_add_u32 s59, s62, 57344
    buffer_load_dword v129, v20, s[24:27], s59 offen
    s_add_u32 s59, s62, 41472
    buffer_load_dword v130, v20, s[24:27], s59 offen
    s_add_u32 s59, s62, 57856
    buffer_load_dword v131, v20, s[24:27], s59 offen
    s_add_u32 s59, s62, 41984
    buffer_load_dword v132, v20, s[24:27], s59 offen
    s_add_u32 s59, s62, 58368
    buffer_load_dword v133, v20, s[24:27], s59 offen
    s_add_u32 s59, s62, 42496
    buffer_load_dword v134, v20, s[24:27], s59 offen
    s_add_u32 s59, s62, 58880
    buffer_load_dword v135, v20, s[24:27], s59 offen
    s_mov_b32 s64, 0x05040100
    s_mov_b32 s65, 0x07060302
    s_waitcnt vmcnt(24)
    v_perm_b32 v136, v105, v104, s64
    v_perm_b32 v137, v107, v106, s64
    v_perm_b32 v138, v109, v108, s64
    v_perm_b32 v139, v111, v110, s64
    s_add_u32 s59, s63, 0
    buffer_store_dwordx4 v[136:139], v21, s[28:31], s59 offen sc1
    v_perm_b32 v140, v105, v104, s65
    v_perm_b32 v141, v107, v106, s65
    v_perm_b32 v142, v109, v108, s65
    v_perm_b32 v143, v111, v110, s65
    s_add_u32 s59, s63, 1024
    buffer_store_dwordx4 v[140:143], v21, s[28:31], s59 offen sc1
    s_waitcnt vmcnt(18)
    v_perm_b32 v144, v113, v112, s64
    v_perm_b32 v145, v115, v114, s64
    v_perm_b32 v146, v117, v116, s64
    v_perm_b32 v147, v119, v118, s64
    s_add_u32 s59, s63, 2048
    buffer_store_dwordx4 v[144:147], v21, s[28:31], s59 offen sc1
    v_perm_b32 v148, v113, v112, s65
    v_perm_b32 v149, v115, v114, s65
    v_perm_b32 v150, v117, v116, s65
    v_perm_b32 v151, v119, v118, s65
    s_add_u32 s59, s63, 3072
    buffer_store_dwordx4 v[148:151], v21, s[28:31], s59 offen sc1
    s_waitcnt vmcnt(12)
    v_perm_b32 v152, v121, v120, s64
    v_perm_b32 v153, v123, v122, s64
    v_perm_b32 v154, v125, v124, s64
    v_perm_b32 v155, v127, v126, s64
    s_add_u32 s59, s63, 4096
    buffer_store_dwordx4 v[152:155], v21, s[28:31], s59 offen sc1
    v_perm_b32 v156, v121, v120, s65
    v_perm_b32 v157, v123, v122, s65
    v_perm_b32 v158, v125, v124, s65
    v_perm_b32 v159, v127, v126, s65
    s_add_u32 s59, s63, 5120
    buffer_store_dwordx4 v[156:159], v21, s[28:31], s59 offen sc1
    s_waitcnt vmcnt(6)
    v_perm_b32 v160, v129, v128, s64
    v_perm_b32 v161, v131, v130, s64
    v_perm_b32 v162, v133, v132, s64
    v_perm_b32 v163, v135, v134, s64
    s_add_u32 s59, s63, 6144
    buffer_store_dwordx4 v[160:163], v21, s[28:31], s59 offen sc1
    v_perm_b32 v164, v129, v128, s65
    v_perm_b32 v165, v131, v130, s65
    v_perm_b32 v166, v133, v132, s65
    v_perm_b32 v167, v135, v134, s65
    s_add_u32 s59, s63, 7168
    buffer_store_dwordx4 v[164:167], v21, s[28:31], s59 offen sc1
    s_endpgm
K1_CPREP:
    s_cmp_ge_u32 s58, 8
    s_cbranch_scc1 K1_END
    v_and_b32 v3, 1, v1
    v_lshlrev_b32 v3, 6, v3
    v_bfe_u32 v4, v1, 2, 1
    v_lshl_add_u32 v3, v4, 5, v3
    v_bfe_u32 v4, v1, 3, 1
    v_lshl_add_u32 v3, v4, 2, v3
    v_bfe_u32 v4, v1, 1, 1
    v_lshl_add_u32 v3, v4, 1, v3
    v_bfe_u32 v2, v1, 4, 1
    v_lshrrev_b32 v4, 5, v1
    v_cmp_eq_u32 vcc, v2, v4
    v_lshlrev_b32 v2, 3, v1
    s_lshl_b32 s59, s58, 7
    s_lshl_b32 s60, s58, 9
    s_mov_b32 s64, 3216550459
    s_waitcnt lgkmcnt(0)
    s_add_u32 s24, s12, 524288
    s_addc_u32 s25, s13, 0
    s_and_b32 s25, s25, 0xffff
    s_mov_b32 s26, 1024
    s_mov_b32 s27, 0x20000
    s_add_u32 s28, s20, 33980416
    s_addc_u32 s29, s21, 0
    s_and_b32 s29, s29, 0xffff
    s_mov_b32 s30, 4096
    s_mov_b32 s31, 0x20000
    buffer_load_ushort v8, v3, s[24:27], s59 offen offset:0
    buffer_load_ushort v9, v3, s[24:27], s59 offen offset:8
    buffer_load_ushort v10, v3, s[24:27], s59 offen offset:16
    buffer_load_ushort v11, v3, s[24:27], s59 offen offset:24
    s_waitcnt vmcnt(0)
    v_lshlrev_b32 v8, 16, v8
    v_mul_f32 v8, s64, v8
    v_lshlrev_b32 v9, 16, v9
    v_mul_f32 v9, s64, v9
    v_lshlrev_b32 v10, 16, v10
    v_mul_f32 v10, s64, v10
    v_lshlrev_b32 v11, 16, v11
    v_mul_f32 v11, s64, v11
    v_cvt_pk_bf16_f32 v12, v8, v9
    v_cvt_pk_bf16_f32 v13, v10, v11
    v_cndmask_b32 v12, 0, v12, vcc
    v_cndmask_b32 v13, 0, v13, vcc
    buffer_store_dwordx2 v[12:13], v2, s[28:31], s60 offen sc1
    s_endpgm
K1_SORT:
    s_mov_b32 s58, s2
    v_lshlrev_b32 v108, 4, v0
    v_lshlrev_b32 v109, 3, v0
    s_mul_i32 s59, s58, 20000
    s_mul_i32 s60, s58, 10000
    v_mov_b32 v72, 0
    v_mov_b32 v73, 0
    v_mov_b32 v74, 0
    v_mov_b32 v75, 0
    v_lshlrev_b32 v2, 2, v1
    s_waitcnt lgkmcnt(0)
    s_add_u32 s24, s10, s59
    s_addc_u32 s25, s11, 0
    s_and_b32 s25, s25, 0xffff
    s_mov_b32 s26, 20000
    s_mov_b32 s27, 0x20000
    s_mov_b32 s62, 0
    buffer_load_dwordx4 v[8:11], v108, s[24:27], s62 offen
    s_mov_b32 s62, 8192
    buffer_load_dwordx4 v[12:15], v108, s[24:27], s62 offen
    s_mov_b32 s62, 16384
    buffer_load_dwordx4 v[16:19], v108, s[24:27], s62 offen
    ds_write_b128 v108, v[72:75] offset:0
    ds_write_b128 v108, v[72:75] offset:8192
    ds_write_b128 v108, v[72:75] offset:45056
    ds_write_b128 v108, v[72:75] offset:53248
    s_waitcnt lgkmcnt(0)
    s_barrier
    s_add_u32 s28, s8, s59
    s_addc_u32 s29, s9, 0
    s_and_b32 s29, s29, 0xffff
    s_mov_b32 s30, 20000
    s_mov_b32 s31, 0x20000
    s_add_u32 s32, s6, s60
    s_addc_u32 s33, s7, 0
    s_and_b32 s33, s33, 0xffff
    s_mov_b32 s34, 10000
    s_mov_b32 s35, 0x20000
    s_mov_b32 s59, 0
    buffer_load_dwordx4 v[20:23], v108, s[28:31], s59 offen
    s_mov_b32 s59, 8192
    buffer_load_dwordx4 v[24:27], v108, s[28:31], s59 offen
    s_mov_b32 s59, 16384
    buffer_load_dwordx4 v[28:31], v108, s[28:31], s59 offen
    s_mov_b32 s60, 0
    buffer_load_dwordx2 v[32:33], v109, s[32:35], s60 offen
    s_mov_b32 s60, 4096
    buffer_load_dwordx2 v[34:35], v109, s[32:35], s60 offen
    s_mov_b32 s60, 8192
    buffer_load_dwordx2 v[36:37], v109, s[32:35], s60 offen
    s_add_u32 s36, s20, 31326208
    s_addc_u32 s37, s21, 0
    s_and_b32 s37, s37, 0xffff
    s_mov_b32 s38, 917504
    s_mov_b32 s39, 0x20000
    s_add_u32 s40, s20, 32243712
    s_addc_u32 s41, s21, 0
    s_and_b32 s41, s41, 0xffff
    s_mov_b32 s42, 458752
    s_mov_b32 s43, 0x20000
    s_mov_b32 s44, s52
    s_and_b32 s45, s53, 0xffff
    s_mov_b32 s46, 256
    s_mov_b32 s47, 0x20000
    s_mov_b32 s59, 13401
    s_mov_b32 s60, 4294966983
    s_mov_b32 s66, 0xffff0000
    v_mov_b32 v6, 1
    v_cmp_gt_u32 vcc, 226, v0
    s_mov_b64 s[64:65], vcc
    s_mov_b32 s62, 224
    s_waitcnt vmcnt(8)
    v_mul_u32_u24 v56, s59, v8
    v_lshrrev_b32 v56, 22, v56
    v_lshlrev_b32 v40, 2, v56
    ds_add_rtn_u32 v40, v40, v6 offset:0
    v_mad_i32_i24 v8, v56, s60, v8
    v_lshl_add_u32 v8, v8, 5, 16
    v_mul_u32_u24 v57, s59, v9
    v_lshrrev_b32 v57, 22, v57
    v_lshlrev_b32 v41, 2, v57
    ds_add_rtn_u32 v41, v41, v6 offset:0
    v_mad_i32_i24 v9, v57, s60, v9
    v_lshl_add_u32 v9, v9, 5, 16
    v_mul_u32_u24 v58, s59, v10
    v_lshrrev_b32 v58, 22, v58
    v_lshlrev_b32 v42, 2, v58
    ds_add_rtn_u32 v42, v42, v6 offset:0
    v_mad_i32_i24 v10, v58, s60, v10
    v_lshl_add_u32 v10, v10, 5, 16
    v_mul_u32_u24 v59, s59, v11
    v_lshrrev_b32 v59, 22, v59
    v_lshlrev_b32 v43, 2, v59
    ds_add_rtn_u32 v43, v43, v6 offset:0
    v_mad_i32_i24 v11, v59, s60, v11
    v_lshl_add_u32 v11, v11, 5, 16
    s_waitcnt vmcnt(7)
    v_mul_u32_u24 v60, s59, v12
    v_lshrrev_b32 v60, 22, v60
    v_lshlrev_b32 v44, 2, v60
    ds_add_rtn_u32 v44, v44, v6 offset:0
    v_mad_i32_i24 v12, v60, s60, v12
    v_lshl_add_u32 v12, v12, 5, 16
    v_mul_u32_u24 v61, s59, v13
    v_lshrrev_b32 v61, 22, v61
    v_lshlrev_b32 v45, 2, v61
    ds_add_rtn_u32 v45, v45, v6 offset:0
    v_mad_i32_i24 v13, v61, s60, v13
    v_lshl_add_u32 v13, v13, 5, 16
    v_mul_u32_u24 v62, s59, v14
    v_lshrrev_b32 v62, 22, v62
    v_lshlrev_b32 v46, 2, v62
    ds_add_rtn_u32 v46, v46, v6 offset:0
    v_mad_i32_i24 v14, v62, s60, v14
    v_lshl_add_u32 v14, v14, 5, 16
    v_mul_u32_u24 v63, s59, v15
    v_lshrrev_b32 v63, 22, v63
    v_lshlrev_b32 v47, 2, v63
    ds_add_rtn_u32 v47, v47, v6 offset:0
    v_mad_i32_i24 v15, v63, s60, v15
    v_lshl_add_u32 v15, v15, 5, 16
    s_waitcnt vmcnt(6)
    s_mov_b64 exec, s[64:65]
    v_mul_u32_u24 v64, s59, v16
    v_lshrrev_b32 v64, 22, v64
    v_lshlrev_b32 v48, 2, v64
    ds_add_rtn_u32 v48, v48, v6 offset:0
    v_mad_i32_i24 v16, v64, s60, v16
    v_lshl_add_u32 v16, v16, 5, 16
    v_mul_u32_u24 v65, s59, v17
    v_lshrrev_b32 v65, 22, v65
    v_lshlrev_b32 v49, 2, v65
    ds_add_rtn_u32 v49, v49, v6 offset:0
    v_mad_i32_i24 v17, v65, s60, v17
    v_lshl_add_u32 v17, v17, 5, 16
    v_mul_u32_u24 v66, s59, v18
    v_lshrrev_b32 v66, 22, v66
    v_lshlrev_b32 v50, 2, v66
    ds_add_rtn_u32 v50, v50, v6 offset:0
    v_mad_i32_i24 v18, v66, s60, v18
    v_lshl_add_u32 v18, v18, 5, 16
    v_mul_u32_u24 v67, s59, v19
    v_lshrrev_b32 v67, 22, v67
    v_lshlrev_b32 v51, 2, v67
    ds_add_rtn_u32 v51, v51, v6 offset:0
    v_mad_i32_i24 v19, v67, s60, v19
    v_lshl_add_u32 v19, v19, 5, 16
    s_mov_b64 exec, -1
    s_mov_b32 s59, 52432
    s_waitcnt vmcnt(5)
    v_mul_u32_u24 v4, s59, v20
    v_lshrrev_b32 v4, 26, v4
    v_lshl_add_u32 v8, v4, 2, v8
    s_waitcnt lgkmcnt(11)
    v_min_u32 v40, 223, v40
    v_mad_u32_u24 v40, v56, s62, v40
    v_lshlrev_b32 v56, 1, v40
    ds_write_b16 v56, v8 offset:256
    v_mul_u32_u24 v4, s59, v21
    v_lshrrev_b32 v4, 26, v4
    v_lshl_add_u32 v9, v4, 2, v9
    s_waitcnt lgkmcnt(11)
    v_min_u32 v41, 223, v41
    v_mad_u32_u24 v41, v57, s62, v41
    v_lshlrev_b32 v57, 1, v41
    ds_write_b16 v57, v9 offset:256
    v_mul_u32_u24 v4, s59, v22
    v_lshrrev_b32 v4, 26, v4
    v_lshl_add_u32 v10, v4, 2, v10
    s_waitcnt lgkmcnt(11)
    v_min_u32 v42, 223, v42
    v_mad_u32_u24 v42, v58, s62, v42
    v_lshlrev_b32 v58, 1, v42
    ds_write_b16 v58, v10 offset:256
    v_mul_u32_u24 v4, s59, v23
    v_lshrrev_b32 v4, 26, v4
    v_lshl_add_u32 v11, v4, 2, v11
    s_waitcnt lgkmcnt(11)
    v_min_u32 v43, 223, v43
    v_mad_u32_u24 v43, v59, s62, v43
    v_lshlrev_b32 v59, 1, v43
    ds_write_b16 v59, v11 offset:256
    s_waitcnt vmcnt(4)
    v_mul_u32_u24 v4, s59, v24
    v_lshrrev_b32 v4, 26, v4
    v_lshl_add_u32 v12, v4, 2, v12
    s_waitcnt lgkmcnt(11)
    v_min_u32 v44, 223, v44
    v_mad_u32_u24 v44, v60, s62, v44
    v_lshlrev_b32 v60, 1, v44
    ds_write_b16 v60, v12 offset:256
    v_mul_u32_u24 v4, s59, v25
    v_lshrrev_b32 v4, 26, v4
    v_lshl_add_u32 v13, v4, 2, v13
    s_waitcnt lgkmcnt(11)
    v_min_u32 v45, 223, v45
    v_mad_u32_u24 v45, v61, s62, v45
    v_lshlrev_b32 v61, 1, v45
    ds_write_b16 v61, v13 offset:256
    v_mul_u32_u24 v4, s59, v26
    v_lshrrev_b32 v4, 26, v4
    v_lshl_add_u32 v14, v4, 2, v14
    s_waitcnt lgkmcnt(11)
    v_min_u32 v46, 223, v46
    v_mad_u32_u24 v46, v62, s62, v46
    v_lshlrev_b32 v62, 1, v46
    ds_write_b16 v62, v14 offset:256
    v_mul_u32_u24 v4, s59, v27
    v_lshrrev_b32 v4, 26, v4
    v_lshl_add_u32 v15, v4, 2, v15
    s_waitcnt lgkmcnt(11)
    v_min_u32 v47, 223, v47
    v_mad_u32_u24 v47, v63, s62, v47
    v_lshlrev_b32 v63, 1, v47
    ds_write_b16 v63, v15 offset:256
    s_mov_b64 exec, s[64:65]
    s_waitcnt vmcnt(3)
    v_mul_u32_u24 v4, s59, v28
    v_lshrrev_b32 v4, 26, v4
    v_lshl_add_u32 v16, v4, 2, v16
    s_waitcnt lgkmcnt(11)
    v_min_u32 v48, 223, v48
    v_mad_u32_u24 v48, v64, s62, v48
    v_lshlrev_b32 v64, 1, v48
    ds_write_b16 v64, v16 offset:256
    v_mul_u32_u24 v4, s59, v29
    v_lshrrev_b32 v4, 26, v4
    v_lshl_add_u32 v17, v4, 2, v17
    s_waitcnt lgkmcnt(11)
    v_min_u32 v49, 223, v49
    v_mad_u32_u24 v49, v65, s62, v49
    v_lshlrev_b32 v65, 1, v49
    ds_write_b16 v65, v17 offset:256
    v_mul_u32_u24 v4, s59, v30
    v_lshrrev_b32 v4, 26, v4
    v_lshl_add_u32 v18, v4, 2, v18
    s_waitcnt lgkmcnt(11)
    v_min_u32 v50, 223, v50
    v_mad_u32_u24 v50, v66, s62, v50
    v_lshlrev_b32 v66, 1, v50
    ds_write_b16 v66, v18 offset:256
    v_mul_u32_u24 v4, s59, v31
    v_lshrrev_b32 v4, 26, v4
    v_lshl_add_u32 v19, v4, 2, v19
    s_waitcnt lgkmcnt(11)
    v_min_u32 v51, 223, v51
    v_mad_u32_u24 v51, v67, s62, v51
    v_lshlrev_b32 v67, 1, v51
    ds_write_b16 v67, v19 offset:256
    s_mov_b64 exec, -1
    s_mul_i32 s59, s58, 896
    s_mul_i32 s60, s58, 448
    s_mov_b32 s62, 27776
    s_mov_b32 s63, 13888
    v_add_u32 v4, 0, v0
    v_mul_u32_u24 v4, 2341, v4
    v_lshrrev_b32 v4, 16, v4
    v_mad_u32_u24 v104, v4, s63, v108
    v_add_u32 v104, 0, v104
    v_lshlrev_b32 v96, 2, v4
    v_add_u32 v4, 512, v0
    v_mul_u32_u24 v4, 2341, v4
    v_lshrrev_b32 v4, 16, v4
    v_mad_u32_u24 v105, v4, s63, v108
    v_add_u32 v105, 8192, v105
    v_lshlrev_b32 v97, 2, v4
    s_waitcnt lgkmcnt(0)
    s_barrier
    ds_read_b128 v[88:91], v108 offset:256
    ds_read_b32 v96, v96 offset:0
    ds_read_b128 v[92:95], v108 offset:8448
    ds_read_b32 v97, v97 offset:0
    s_waitcnt lgkmcnt(2)
    v_cmp_ge_u32 vcc, 224, v96
    s_nop 1
    v_cndmask_b32 v88, -1, v88, vcc
    buffer_store_dwordx4 v[88:91], v104, s[40:43], s60 offen sc1
    s_waitcnt lgkmcnt(0)
    v_cmp_ge_u32 vcc, 224, v97
    s_nop 1
    v_cndmask_b32 v92, -1, v92, vcc
    buffer_store_dwordx4 v[92:95], v105, s[40:43], s60 offen sc1
    s_waitcnt vmcnt(4)
    v_lshl_or_b32 v20, v32, 16, v20
    v_lshlrev_b32 v40, 2, v40
    ds_write_b32 v40, v20 offset:14592
    v_and_or_b32 v21, v32, s66, v21
    v_lshlrev_b32 v41, 2, v41
    ds_write_b32 v41, v21 offset:14592
    v_lshl_or_b32 v22, v33, 16, v22
    v_lshlrev_b32 v42, 2, v42
    ds_write_b32 v42, v22 offset:14592
    v_and_or_b32 v23, v33, s66, v23
    v_lshlrev_b32 v43, 2, v43
    ds_write_b32 v43, v23 offset:14592
    s_waitcnt vmcnt(3)
    v_lshl_or_b32 v24, v34, 16, v24
    v_lshlrev_b32 v44, 2, v44
    ds_write_b32 v44, v24 offset:14592
    v_and_or_b32 v25, v34, s66, v25
    v_lshlrev_b32 v45, 2, v45
    ds_write_b32 v45, v25 offset:14592
    v_lshl_or_b32 v26, v35, 16, v26
    v_lshlrev_b32 v46, 2, v46
    ds_write_b32 v46, v26 offset:14592
    v_and_or_b32 v27, v35, s66, v27
    v_lshlrev_b32 v47, 2, v47
    ds_write_b32 v47, v27 offset:14592
    s_waitcnt vmcnt(2)
    s_mov_b64 exec, s[64:65]
    v_lshl_or_b32 v28, v36, 16, v28
    v_lshlrev_b32 v48, 2, v48
    ds_write_b32 v48, v28 offset:14592
    v_and_or_b32 v29, v36, s66, v29
    v_lshlrev_b32 v49, 2, v49
    ds_write_b32 v49, v29 offset:14592
    v_lshl_or_b32 v30, v37, 16, v30
    v_lshlrev_b32 v50, 2, v50
    ds_write_b32 v50, v30 offset:14592
    v_and_or_b32 v31, v37, s66, v31
    v_lshlrev_b32 v51, 2, v51
    ds_write_b32 v51, v31 offset:14592
    s_mov_b64 exec, -1
    v_add_u32 v4, 0, v0
    v_mul_u32_u24 v4, 2341, v4
    v_lshrrev_b32 v4, 17, v4
    v_mad_u32_u24 v100, v4, s62, v108
    v_add_u32 v100, 0, v100
    v_add_u32 v4, 512, v0
    v_mul_u32_u24 v4, 2341, v4
    v_lshrrev_b32 v4, 17, v4
    v_mad_u32_u24 v101, v4, s62, v108
    v_add_u32 v101, 8192, v101
    v_add_u32 v4, 1024, v0
    v_mul_u32_u24 v4, 2341, v4
    v_lshrrev_b32 v4, 17, v4
    v_mad_u32_u24 v102, v4, s62, v108
    v_add_u32 v102, 16384, v102
    v_add_u32 v4, 1536, v0
    v_mul_u32_u24 v4, 2341, v4
    v_lshrrev_b32 v4, 17, v4
    v_mad_u32_u24 v103, v4, s62, v108
    v_add_u32 v103, 24576, v103
    s_lshl_b32 s69, s58, 2
    v_mov_b32 v7, s69
    s_waitcnt vmcnt(0) lgkmcnt(0)
    s_barrier
    s_cmp_lg_u32 s56, 0
    s_cbranch_scc1 K1_F1
    s_mov_b64 exec, 1
    buffer_store_dword v6, v7, s[44:47], 0 offen sc1
    s_mov_b64 exec, -1
K1_F1:
    ds_read_b128 v[72:75], v108 offset:14592
    ds_read_b128 v[76:79], v108 offset:22784
    ds_read_b128 v[80:83], v108 offset:30976
    ds_read_b128 v[84:87], v108 offset:39168
    s_waitcnt lgkmcnt(3)
    buffer_store_dwordx4 v[72:75], v100, s[36:39], s59 offen sc1
    s_waitcnt lgkmcnt(2)
    buffer_store_dwordx4 v[76:79], v101, s[36:39], s59 offen sc1
    s_waitcnt lgkmcnt(1)
    buffer_store_dwordx4 v[80:83], v102, s[36:39], s59 offen sc1
    s_waitcnt lgkmcnt(0)
    buffer_store_dwordx4 v[84:87], v103, s[36:39], s59 offen sc1
    s_mul_i32 s59, s58, 28672
    s_add_u32 s59, s59, 31326208
    s_mul_i32 s60, s58, 14336
    s_add_u32 s60, s60, 32243712
    s_mul_i32 s62, s58, 27648
    s_add_u32 s62, s62, 32702464
    s_lshl_b32 s63, s58, 12
    s_add_u32 s63, s63, 33587200
    s_add_u32 s24, s20, s62
    s_addc_u32 s25, s21, 0
    s_and_b32 s25, s25, 0xffff
    s_mov_b32 s26, 27648
    s_mov_b32 s27, 0x20000
    s_add_u32 s28, s20, s63
    s_addc_u32 s29, s21, 0
    s_and_b32 s29, s29, 0xffff
    s_mov_b32 s30, 3072
    s_mov_b32 s31, 0x20000
    v_mov_b32 v8, 0xffff
    v_mov_b32 v9, 0xffff
    v_mov_b32 v10, 0xffff
    v_mov_b32 v11, 0xffff
    v_add_u32 v2, 67584, v108
    v_mov_b32 v12, 0
    v_mov_b32 v13, 0
    v_mov_b32 v14, 95232
    ds_write_b128 v2, v[8:11] offset:0
    ds_write_b128 v2, v[8:11] offset:8192
    ds_write_b128 v2, v[8:11] offset:16384
    v_add_u32 v3, 92160, v109
    ds_write_b64 v3, v[12:13]
    v_mov_b32 v3, 55568
    ds_write_b32 v3, v14
    buffer_store_dwordx2 v[12:13], v109, s[28:31], 0 offen sc1
    v_mov_b32 v48, 0
    v_mov_b32 v49, 0
    v_mov_b32 v50, 0
    v_mov_b32 v51, 0
    v_mov_b32 v52, 0
    v_mov_b32 v53, 0
    v_mov_b32 v54, 0
    v_mov_b32 v55, 0
    v_mov_b32 v56, 0
    v_mov_b32 v57, 0
    v_mov_b32 v58, 0
    v_mov_b32 v59, 0
    v_mov_b32 v60, 0
    v_mov_b32 v61, 0
    v_mov_b32 v62, 0
    v_mov_b32 v63, 0
    s_waitcnt vmcnt(0) lgkmcnt(0)
    s_add_u32 s36, s20, s59
    s_addc_u32 s37, s21, 0
    s_and_b32 s37, s37, 0xffff
    s_mov_b32 s38, 28672
    s_mov_b32 s39, 0x20000
    s_add_u32 s40, s20, s60
    s_addc_u32 s41, s21, 0
    s_and_b32 s41, s41, 0xffff
    s_mov_b32 s42, 14336
    s_mov_b32 s43, 0x20000
    s_barrier
    v_lshlrev_b32 v110, 2, v1
    s_cmp_lg_u32 s56, 1
    s_cbranch_scc1 K1_F2
    s_mov_b64 exec, 1
    buffer_store_dword v6, v7, s[44:47], 0 offen offset:128 sc1
    s_mov_b64 exec, -1
K1_F2:
    s_cmp_lg_u32 s56, 0
    s_cbranch_scc1 K1_PAI
    s_mov_b32 exec_hi, 0
    buffer_load_dword v111, v110, s[44:47], 0 offen offset:0 sc1
    s_mov_b32 exec_hi, -1
K1_PAI:
    s_cmp_lg_u32 s56, 0
    s_cbranch_scc1 K1_PAX
    s_mov_b32 exec_hi, 0
    s_mov_b32 s71, 0
K1_PAL:
    s_waitcnt vmcnt(0)
    v_cmp_eq_u32 vcc, 0, v111
    s_cbranch_vccz K1_PAD
    buffer_load_dword v111, v110, s[44:47], 0 offen offset:0 sc1
    s_add_u32 s71, s71, 1
    s_cmp_lt_u32 s71, 0x40000
    s_cbranch_scc1 K1_PAL
    s_waitcnt vmcnt(0)
    v_mov_b32 v111, 94720
    ds_write_b32 v111, v6
    s_waitcnt lgkmcnt(0)
K1_PAD:
    s_mov_b64 exec, -1
K1_PAX:
    s_barrier
    s_mov_b32 s59, 0
    buffer_load_dwordx2 v[8:9], v109, s[40:43], s59 offen sc1
    s_mov_b32 s59, 4096
    buffer_load_dwordx2 v[10:11], v109, s[40:43], s59 offen sc1
    s_mov_b32 s59, 8192
    buffer_load_dwordx2 v[12:13], v109, s[40:43], s59 offen sc1
    s_mov_b32 s59, 12288
    buffer_load_dwordx2 v[14:15], v109, s[40:43], s59 offen sc1
    v_mov_b32 v4, 0
    s_waitcnt vmcnt(3)
    s_cmp_lg_u32 s56, 7
    s_cbranch_scc1 K1_PBI
    s_mov_b32 exec_hi, 0
    buffer_load_dword v111, v110, s[44:47], 0 offen offset:128 sc1
    s_mov_b32 exec_hi, -1
K1_PBI:
    v_bfe_i32 v32, v8, 0, 16
    v_ashrrev_i32 v33, 16, v8
    v_bfe_i32 v34, v9, 0, 16
    v_ashrrev_i32 v35, 16, v9
    v_min_i32 v4, v32, v4
    v_cmpx_lt_i32 vcc, 0, v32
    ds_add_rtn_u32 v48, v32, v6 offset:45056
    s_mov_b64 exec, -1
    v_cmpx_lt_i32 vcc, 0, v33
    ds_add_rtn_u32 v49, v33, v6 offset:45056
    s_mov_b64 exec, -1
    v_cmpx_lt_i32 vcc, 0, v34
    ds_add_rtn_u32 v50, v34, v6 offset:45056
    s_mov_b64 exec, -1
    v_cmpx_lt_i32 vcc, 0, v35
    ds_add_rtn_u32 v51, v35, v6 offset:45056
    s_mov_b64 exec, -1
    s_waitcnt vmcnt(2)
    v_bfe_i32 v36, v10, 0, 16
    v_ashrrev_i32 v37, 16, v10
    v_bfe_i32 v38, v11, 0, 16
    v_ashrrev_i32 v39, 16, v11
    v_min_i32 v4, v36, v4
    v_cmpx_lt_i32 vcc, 0, v36
    ds_add_rtn_u32 v52, v36, v6 offset:45056
    s_mov_b64 exec, -1
    v_cmpx_lt_i32 vcc, 0, v37
    ds_add_rtn_u32 v53, v37, v6 offset:45056
    s_mov_b64 exec, -1
    v_cmpx_lt_i32 vcc, 0, v38
    ds_add_rtn_u32 v54, v38, v6 offset:45056
    s_mov_b64 exec, -1
    v_cmpx_lt_i32 vcc, 0, v39
    ds_add_rtn_u32 v55, v39, v6 offset:45056
    s_mov_b64 exec, -1
    s_waitcnt vmcnt(1)
    v_bfe_i32 v40, v12, 0, 16
    v_ashrrev_i32 v41, 16, v12
    v_bfe_i32 v42, v13, 0, 16
    v_ashrrev_i32 v43, 16, v13
    v_min_i32 v4, v40, v4
    v_cmpx_lt_i32 vcc, 0, v40
    ds_add_rtn_u32 v56, v40, v6 offset:45056
    s_mov_b64 exec, -1
    v_cmpx_lt_i32 vcc, 0, v41
    ds_add_rtn_u32 v57, v41, v6 offset:45056
    s_mov_b64 exec, -1
    v_cmpx_lt_i32 vcc, 0, v42
    ds_add_rtn_u32 v58, v42, v6 offset:45056
    s_mov_b64 exec, -1
    v_cmpx_lt_i32 vcc, 0, v43
    ds_add_rtn_u32 v59, v43, v6 offset:45056
    s_mov_b64 exec, -1
    s_waitcnt vmcnt(0)
    v_bfe_i32 v44, v14, 0, 16
    v_ashrrev_i32 v45, 16, v14
    v_bfe_i32 v46, v15, 0, 16
    v_ashrrev_i32 v47, 16, v15
    v_min_i32 v4, v44, v4
    s_cmp_ge_u32 s56, 4
    s_cbranch_scc1 K1_SK1
    v_cmpx_lt_i32 vcc, 0, v44
    ds_add_rtn_u32 v60, v44, v6 offset:45056
    s_mov_b64 exec, -1
    v_cmpx_lt_i32 vcc, 0, v45
    ds_add_rtn_u32 v61, v45, v6 offset:45056
    s_mov_b64 exec, -1
    v_cmpx_lt_i32 vcc, 0, v46
    ds_add_rtn_u32 v62, v46, v6 offset:45056
    s_mov_b64 exec, -1
    v_cmpx_lt_i32 vcc, 0, v47
    ds_add_rtn_u32 v63, v47, v6 offset:45056
    s_mov_b64 exec, -1
K1_SK1:
    v_mov_b32 v2, 94720
    v_cmpx_gt_i32 vcc, 0, v4
    ds_write_b32 v2, v6
    s_mov_b64 exec, -1
    s_waitcnt lgkmcnt(0)
    s_cmp_lg_u32 s56, 7
    s_cbranch_scc1 K1_PBX
    s_mov_b32 exec_hi, 0
    s_mov_b32 s71, 0
K1_PBL:
    s_waitcnt vmcnt(0)
    v_cmp_eq_u32 vcc, 0, v111
    s_cbranch_vccz K1_PBD
    buffer_load_dword v111, v110, s[44:47], 0 offen offset:128 sc1
    s_add_u32 s71, s71, 1
    s_cmp_lt_u32 s71, 0x40000
    s_cbranch_scc1 K1_PBL
    s_waitcnt vmcnt(0)
    v_mov_b32 v111, 94720
    ds_write_b32 v111, v6
    s_waitcnt lgkmcnt(0)
K1_PBD:
    s_mov_b64 exec, -1
K1_PBX:
    s_barrier
    s_mov_b32 s59, 0
    buffer_load_dwordx4 v[16:19], v108, s[36:39], s59 offen sc1
    s_mov_b32 s59, 8192
    buffer_load_dwordx4 v[20:23], v108, s[36:39], s59 offen sc1
    s_mov_b32 s59, 16384
    buffer_load_dwordx4 v[24:27], v108, s[36:39], s59 offen sc1
    s_mov_b32 s59, 24576
    buffer_load_dwordx4 v[28:31], v108, s[36:39], s59 offen sc1
    s_cmp_ge_u32 s56, 5
    s_cbranch_scc1 K1_D1
    v_lshlrev_b32 v3, 5, v0
    ds_read_b128 v[72:75], v3 offset:45072
    ds_read_b128 v[76:79], v3 offset:45088
    s_waitcnt lgkmcnt(0)
    v_add_u32 v73, v73, v72
    v_add_u32 v74, v74, v73
    v_add_u32 v75, v75, v74
    v_add_u32 v76, v76, v75
    v_add_u32 v77, v77, v76
    v_add_u32 v78, v78, v77
    v_add_u32 v65, v79, v78
    v_cmp_lt_u32 s[64:65], 48, v65
    v_min_u32 v65, 48, v65
    v_sub_u32 v67, 63, v65
    v_lshlrev_b32 v67, 2, v67
    ds_add_rtn_u32 v66, v67, v6 offset:55312
    s_mov_b64 exec, s[64:65]
    ds_write_b32 v2, v6
    s_mov_b64 exec, -1
    s_waitcnt lgkmcnt(0)
K1_D1:
    s_barrier
    s_cmp_ge_u32 s56, 5
    s_cbranch_scc1 K1_D2
    v_lshlrev_b32 v68, 2, v1
    ds_read_b32 v69, v68 offset:55312
    s_waitcnt lgkmcnt(0)
    v_mov_b32 v68, v69
    s_nop 1
    v_add_u32_dpp v68, v68, v68 row_shr:1 row_mask:0xf bank_mask:0xf bound_ctrl:1
    s_nop 1
    v_add_u32_dpp v68, v68, v68 row_shr:2 row_mask:0xf bank_mask:0xf bound_ctrl:1
    s_nop 1
    v_add_u32_dpp v68, v68, v68 row_shr:4 row_mask:0xf bank_mask:0xf bound_ctrl:1
    s_nop 1
    v_add_u32_dpp v68, v68, v68 row_shr:8 row_mask:0xf bank_mask:0xf bound_ctrl:1
    s_nop 1
    v_add_u32_dpp v68, v68, v68 row_bcast:15 row_mask:0xa bank_mask:0xf
    s_nop 1
    v_add_u32_dpp v68, v68, v68 row_bcast:31 row_mask:0xc bank_mask:0xf
    s_nop 1
    v_sub_u32 v68, v68, v69
    ds_bpermute_b32 v70, v67, v68
    v_lshlrev_b32 v64, 16, v0
    s_waitcnt lgkmcnt(0)
    v_add_u32 v70, v70, v66
    v_lshlrev_b32 v71, 3, v70
    v_add_u32 v71, 92160, v71
    ds_write_b64 v71, v[64:65]
    s_waitcnt lgkmcnt(0)
K1_D2:
    s_barrier
    s_cmp_ge_u32 s56, 5
    s_cbranch_scc1 K1_D3
    v_lshlrev_b32 v68, 6, v1
    v_add_u32 v68, 92160, v68
    ds_read_b32 v69, v68 offset:4
    v_cmp_gt_u32 vcc, 40, v1
    s_waitcnt lgkmcnt(0)
    s_nop 0
    v_cndmask_b32 v69, 0, v69, vcc
    v_mov_b32 v68, v69
    s_nop 1
    v_add_u32_dpp v68, v68, v68 row_shr:1 row_mask:0xf bank_mask:0xf bound_ctrl:1
    s_nop 1
    v_add_u32_dpp v68, v68, v68 row_shr:2 row_mask:0xf bank_mask:0xf bound_ctrl:1
    s_nop 1
    v_add_u32_dpp v68, v68, v68 row_shr:4 row_mask:0xf bank_mask:0xf bound_ctrl:1
    s_nop 1
    v_add_u32_dpp v68, v68, v68 row_shr:8 row_mask:0xf bank_mask:0xf bound_ctrl:1
    s_nop 1
    v_add_u32_dpp v68, v68, v68 row_bcast:15 row_mask:0xa bank_mask:0xf
    s_nop 1
    v_add_u32_dpp v68, v68, v68 row_bcast:31 row_mask:0xc bank_mask:0xf
    s_nop 1
    v_readlane_b32 s59, v68, 63
    v_sub_u32 v68, v68, v69
    v_lshlrev_b32 v68, 5, v68
    v_lshrrev_b32 v69, 3, v70
    v_lshlrev_b32 v69, 2, v69
    ds_bpermute_b32 v69, v69, v68
    v_and_b32 v70, 7, v70
    s_cmp_le_u32 s59, 760
    s_cbranch_scc1 K1_FITS
    ds_write_b32 v2, v6
K1_FITS:
    s_waitcnt lgkmcnt(0)
    v_lshl_add_u32 v69, v70, 2, v69
    v_add_u32 v68, 67584, v69
    ds_write_b16 v71, v69
    v_lshl_add_u32 v79, v78, 5, v68
    v_lshl_add_u32 v78, v77, 5, v68
    v_lshl_add_u32 v77, v76, 5, v68
    v_lshl_add_u32 v76, v75, 5, v68
    v_lshl_add_u32 v75, v74, 5, v68
    v_lshl_add_u32 v74, v73, 5, v68
    v_lshl_add_u32 v73, v72, 5, v68
    v_mov_b32 v72, v68
    ds_write_b128 v3, v[72:75] offset:55584
    ds_write_b128 v3, v[76:79] offset:55600
    s_waitcnt lgkmcnt(0)
K1_D3:
    s_barrier
    ds_read_b32 v4, v2
    ds_read_b32 v8, v32 offset:55568
    ds_read_b32 v9, v33 offset:55568
    ds_read_b32 v10, v34 offset:55568
    ds_read_b32 v11, v35 offset:55568
    ds_read_b32 v12, v36 offset:55568
    ds_read_b32 v13, v37 offset:55568
    ds_read_b32 v14, v38 offset:55568
    ds_read_b32 v15, v39 offset:55568
    s_waitcnt lgkmcnt(8)
    v_readfirstlane_b32 s59, v4
    s_cmp_lg_u32 s59, 0
    s_cbranch_scc1 K1_NOSC
    s_waitcnt vmcnt(3) lgkmcnt(7)
    v_lshl_add_u32 v48, v48, 5, v8
    ds_read_b32 v8, v40 offset:55568
    ds_write_b32 v48, v16
    s_waitcnt lgkmcnt(8)
    v_lshl_add_u32 v49, v49, 5, v9
    ds_read_b32 v9, v41 offset:55568
    ds_write_b32 v49, v17
    s_waitcnt lgkmcnt(9)
    v_lshl_add_u32 v50, v50, 5, v10
    ds_read_b32 v10, v42 offset:55568
    ds_write_b32 v50, v18
    s_waitcnt lgkmcnt(10)
    v_lshl_add_u32 v51, v51, 5, v11
    ds_read_b32 v11, v43 offset:55568
    ds_write_b32 v51, v19
    s_waitcnt vmcnt(2) lgkmcnt(11)
    v_lshl_add_u32 v52, v52, 5, v12
    ds_read_b32 v12, v44 offset:55568
    ds_write_b32 v52, v20
    s_waitcnt lgkmcnt(12)
    v_lshl_add_u32 v53, v53, 5, v13
    ds_read_b32 v13, v45 offset:55568
    ds_write_b32 v53, v21
    s_waitcnt lgkmcnt(13)
    v_lshl_add_u32 v54, v54, 5, v14
    ds_read_b32 v14, v46 offset:55568
    ds_write_b32 v54, v22
    s_waitcnt lgkmcnt(14)
    v_lshl_add_u32 v55, v55, 5, v15
    ds_read_b32 v15, v47 offset:55568
    ds_write_b32 v55, v23
    s_waitcnt vmcnt(1) lgkmcnt(15)
    v_lshl_add_u32 v56, v56, 5, v8
    ds_write_b32 v56, v24
    s_waitcnt lgkmcnt(14)
    v_lshl_add_u32 v57, v57, 5, v9
    ds_write_b32 v57, v25
    s_waitcnt lgkmcnt(13)
    v_lshl_add_u32 v58, v58, 5, v10
    ds_write_b32 v58, v26
    s_waitcnt lgkmcnt(12)
    v_lshl_add_u32 v59, v59, 5, v11
    ds_write_b32 v59, v27
    s_cmp_ge_u32 s56, 4
    s_cbranch_scc1 K1_NOSC
    s_waitcnt vmcnt(0) lgkmcnt(11)
    v_lshl_add_u32 v60, v60, 5, v12
    ds_write_b32 v60, v28
    s_waitcnt lgkmcnt(10)
    v_lshl_add_u32 v61, v61, 5, v13
    ds_write_b32 v61, v29
    s_waitcnt lgkmcnt(9)
    v_lshl_add_u32 v62, v62, 5, v14
    ds_write_b32 v62, v30
    s_waitcnt lgkmcnt(8)
    v_lshl_add_u32 v63, v63, 5, v15
    ds_write_b32 v63, v31
    s_branch K1_SCD
K1_NOSC:
    s_waitcnt vmcnt(0)
K1_SCD:
    s_waitcnt lgkmcnt(0)
    s_barrier
    v_add_u32 v2, 67584, v108
    ds_read_b128 v[16:19], v2 offset:0
    ds_read_b128 v[20:23], v2 offset:8192
    ds_read_b128 v[24:27], v2 offset:16384
    ds_read_b128 v[28:31], v2 offset:24576
    s_waitcnt lgkmcnt(3)
    s_mov_b32 s59, 0
    buffer_store_dwordx4 v[16:19], v108, s[24:27], s59 offen sc1
    s_waitcnt lgkmcnt(2)
    s_mov_b32 s59, 8192
    buffer_store_dwordx4 v[20:23], v108, s[24:27], s59 offen sc1
    s_waitcnt lgkmcnt(1)
    s_mov_b32 s59, 16384
    buffer_store_dwordx4 v[24:27], v108, s[24:27], s59 offen sc1
    s_waitcnt lgkmcnt(0)
    s_mov_b32 s59, 24576
    buffer_store_dwordx4 v[28:31], v108, s[24:27], s59 offen sc1
K1_END:
    s_endpgm
.globl k2_kernel
.p2align 8
.type k2_kernel,@function
k2_kernel:
    s_cmp_ge_u32 s2, 256
    s_cbranch_scc1 K2_END
    s_load_dwordx16 s[4:19], s[0:1], 0
    s_load_dwordx2 s[20:21], s[0:1], 80
    s_load_dwordx2 s[22:23], s[0:1], 64
    v_lshrrev_b32 v2, 6, v0
    v_and_b32 v1, 63, v0
    v_readfirstlane_b32 s52, v2
    s_and_b32 s53, s2, 7
    s_lshr_b32 s54, s2, 3
    s_mul_i32 s56, s54, 313
    s_sub_u32 s55, 10000, s56
    s_min_u32 s55, s55, 313
    s_mul_i32 s57, s54, 27648
    s_add_u32 s57, s57, 32702464
    v_lshlrev_b32 v124, 4, v1
    v_and_b32 v3, 3, v1
    v_lshlrev_b32 v24, 4, v3
    v_lshrrev_b32 v4, 5, v1
    v_lshl_add_u32 v17, v4, 6, v24
    v_mov_b32 v19, v17
    v_mov_b32 v21, v17
    v_mov_b32 v23, v17
    v_mov_b32 v11, v17
    v_lshl_add_u32 v30, v4, 5, 2
    v_and_b32 v29, 28, v1
    v_lshlrev_b32 v29, 1, v29
    v_and_b32 v5, 16, v1
    v_lshlrev_b32 v5, 1, v5
    v_xor_b32 v28, v5, v124
    v_mov_b32 v12, 0x3f80
    v_mov_b32 v13, 0
    v_lshlrev_b64 v[6:7], v24, v[12:13]
    v_mov_b32 v126, 27140
    v_mov_b32 v123, 64
    v_lshlrev_b32 v3, 3, v1
    s_mov_b32 s62, 3216550459
    s_mov_b32 s64, 2071986176
    s_mov_b32 s66, 1.0
    s_mov_b32 s67, 1.0
    s_add_u32 s58, s52, 24
    s_sub_u32 s59, s52, 3
    s_cmp_lt_u32 s52, 3
    s_cselect_b32 s58, s58, s59
    s_mul_i32 s59, s52, 3
    s_sub_u32 s59, s59, 24
    s_cmp_lt_u32 s52, 10
    s_cselect_b32 s58, s58, s59
    s_lshl_b32 s58, s58, 10
    s_mov_b32 m0, s58
    s_waitcnt lgkmcnt(0)
    s_add_u32 s24, s20, s57
    s_addc_u32 s25, s21, 0
    s_and_b32 s25, s25, 0xffff
    s_mov_b32 s26, 27648
    s_mov_b32 s27, 0x20000
    buffer_load_dwordx4 v124, s[24:27], s58 offen lds
    s_cmp_lt_u32 s52, 10
    s_cbranch_scc1 K2_B1
    buffer_load_dwordx4 v124, s[24:27], s58 offen offset:1024 lds
    buffer_load_dwordx4 v124, s[24:27], s58 offen offset:2048 lds
K2_B1:
    s_add_u32 s40, s20, 33980416
    s_addc_u32 s41, s21, 0
    s_and_b32 s41, s41, 0xffff
    s_mov_b32 s42, 4096
    s_mov_b32 s43, 0x20000
    s_lshl_b32 s57, s53, 9
    buffer_load_dwordx2 v[8:9], v3, s[40:43], s57 offen
    s_mul_i32 s57, s53, 1302528
    s_lshl_b32 s58, s56, 7
    s_add_u32 s58, s58, s57
    s_add_u32 s28, s20, s57
    s_addc_u32 s29, s21, 0
    s_and_b32 s29, s29, 0xffff
    s_or_b32 s29, s29, 8388608
    s_mov_b32 s30, 10000
    s_mov_b32 s31, 0x20000
    s_add_u32 s58, s58, 10420224
    s_add_u32 s32, s20, s58
    s_addc_u32 s33, s21, 0
    s_and_b32 s33, s33, 0xffff
    s_or_b32 s33, s33, 8388608
    s_mov_b32 s34, s55
    s_mov_b32 s35, 0x20000
    s_mul_i32 s58, s54, 327680
    s_add_u32 s58, s58, 20840448
    s_add_u32 s36, s20, s58
    s_addc_u32 s37, s21, 0
    s_and_b32 s37, s37, 0xffff
    s_mov_b32 s38, 327680
    s_mov_b32 s39, 0x20000
    s_add_u32 s44, s20, 33718272
    s_addc_u32 s45, s21, 0
    s_and_b32 s45, s45, 0xffff
    s_mov_b32 s46, 262144
    s_mov_b32 s47, 0x20000
    s_lshl_b32 s58, s56, 9
    s_lshl_b32 s57, s55, 9
    s_add_u32 s76, s22, s58
    s_addc_u32 s77, s23, 0
    s_and_b32 s77, s77, 0xffff
    s_mov_b32 s78, s57
    s_mov_b32 s79, 0x20000
    s_lshl_b32 s58, s54, 12
    s_add_u32 s58, s58, 33587200
    s_add_u32 s80, s20, s58
    s_addc_u32 s81, s21, 0
    s_and_b32 s81, s81, 0xffff
    s_mov_b32 s82, 3072
    s_mov_b32 s83, 0x20000
    s_mov_b32 s61, 327680
    s_mov_b32 s84, 0
    s_cmp_ge_u32 s52, 10
    s_cbranch_scc1 K2_B2
    s_waitcnt vmcnt(0)
    s_barrier
    s_branch K2_B3
K2_B2:
    s_barrier
    s_waitcnt vmcnt(0)
    s_mov_b64 exec, 1
    ds_add_u32 v126, v123 offset:108
    s_mov_b64 exec, -1
K2_B3:
    v_mov_b32 v2, 27136
    ds_read_b32 v3, v2
    s_waitcnt lgkmcnt(0)
    v_readfirstlane_b32 s56, v3
    s_lshl_b32 s58, s52, 6
    s_cmp_lg_u32 s56, 0
    s_cbranch_scc1 K2_SLOW
    s_bitcmp1_b32 s52, 2
    s_cselect_b32 s56, 192, 0
    s_xor_b32 s58, s58, s56
    s_cmp_lt_u32 s52, 4
    s_cbranch_scc1 K2_GO
K2_IWA:
    ds_read_b32 v2, v126 offset:108
    s_waitcnt lgkmcnt(0)
    v_readfirstlane_b32 s56, v2
    s_cmp_lt_u32 s56, 384
    s_cbranch_scc1 K2_IWA
K2_GO:
    s_setprio 3
K2_GROUP:
    v_add_u32 v2, s58, v29
    s_mov_b32 s30, 10000
    ds_read_u16 v25, v2 offset:24576
    ds_read_u16 v10, v2 offset:24578
    ds_read_b32 v27, v2 offset:24580
    s_lshr_b32 s59, s58, 6
    s_sub_u32 s59, s59, 16
    s_cmp_lt_u32 s59, 16
    s_cbranch_scc1 K2_PRE
K2_PRED:
    s_waitcnt lgkmcnt(2)
    ds_read_u16 v16, v25 offset:0
    ds_read_u16 v18, v25 offset:32
    ds_read_u16 v20, v25 offset:64
    ds_read_u16 v22, v25 offset:96
    v_add_u32 v26, v25, v30
    s_waitcnt lgkmcnt(4)
    buffer_load_dwordx4 v[104:107], v[10:11], s[32:35], 0 idxen offen
    ds_read_u16 v12, v26 offset:0
    v_readlane_b32 s59, v27, 0
    v_readlane_b32 s60, v27, 28
    s_waitcnt lgkmcnt(4)
    buffer_load_dwordx4 v[72:75], v[16:17], s[28:31], 0 idxen offen
    s_waitcnt lgkmcnt(3)
    buffer_load_dwordx4 v[76:79], v[18:19], s[28:31], 0 idxen offen
    s_waitcnt lgkmcnt(2)
    buffer_load_dwordx4 v[80:83], v[20:21], s[28:31], 0 idxen offen
    s_waitcnt lgkmcnt(1)
    buffer_load_dwordx4 v[84:87], v[22:23], s[28:31], 0 idxen offen
    ds_read_u16 v16, v25 offset:128
    ds_read_u16 v18, v25 offset:160
    s_waitcnt lgkmcnt(2)
    v_lshlrev_b64 v[14:15], v24, v[12:13]
    ds_read_u16 v12, v26 offset:64
    v_rcp_f32 v64, v56
    v_rcp_f32 v65, v57
    v_rcp_f32 v66, v58
    v_rcp_f32 v67, v59
    v_rcp_f32 v68, v60
    v_rcp_f32 v69, v61
    v_rcp_f32 v70, v62
    v_rcp_f32 v71, v63
    v_pk_mul_f32 v[48:49], v[48:49], v[64:65]
    v_pk_mul_f32 v[50:51], v[50:51], v[66:67]
    v_pk_mul_f32 v[52:53], v[52:53], v[68:69]
    v_pk_mul_f32 v[54:55], v[54:55], v[70:71]
    v_cvt_pk_bf16_f32 v64, v48, v49
    v_cvt_pk_bf16_f32 v65, v50, v51
    v_cvt_pk_bf16_f32 v66, v52, v53
    v_cvt_pk_bf16_f32 v67, v54, v55
    buffer_store_dwordx4 v[64:67], v28, s[36:39], s61 offen sc1
    s_waitcnt vmcnt(5)
    v_mfma_f32_4x4x4_16b_bf16 v[32:35], v[6:7], v[104:105], 0
    v_mfma_f32_4x4x4_16b_bf16 v[36:39], v[6:7], v[106:107], 0
    v_mfma_f32_4x4x4_16b_bf16 v[40:43], v[6:7], v[104:105], 0
    v_mfma_f32_4x4x4_16b_bf16 v[44:47], v[6:7], v[106:107], 0
    s_nop 3
    v_mfma_f32_32x32x8_bf16 v[88:103], v[8:9], v[14:15], v[32:47]
    s_lshl_b32 s61, s58, 7
    s_lshl_b32 s56, s53, 10
    s_add_u32 s61, s61, s56
    s_nop 6
    s_waitcnt vmcnt(3)
    v_mfma_f32_4x4x4_16b_bf16 v[88:91], v[6:7], v[72:73], v[88:91]
    v_mfma_f32_4x4x4_16b_bf16 v[92:95], v[6:7], v[74:75], v[92:95]
    v_mfma_f32_4x4x4_16b_bf16 v[96:99], v[6:7], v[76:77], v[96:99]
    v_mfma_f32_4x4x4_16b_bf16 v[100:103], v[6:7], v[78:79], v[100:103]
    s_waitcnt lgkmcnt(0)
    buffer_load_dwordx4 v[72:75], v[16:17], s[28:31], 0 idxen offen
    buffer_load_dwordx4 v[76:79], v[18:19], s[28:31], 0 idxen offen
    v_lshlrev_b64 v[14:15], v24, v[12:13]
    ds_read_u16 v20, v25 offset:192
    ds_read_u16 v22, v25 offset:224
    ds_read_u16 v12, v26 offset:128
    s_cmp_lg_u32 s84, 0
    s_cbranch_scc1 K2_CNT3
K2_CNT3D:
    s_cmp_lt_u32 s58, 1024
    s_cbranch_scc1 K2_PRX
    s_setprio 2
    s_cmp_lt_u32 s58, 1536
    s_cbranch_scc1 K2_PRX
    s_setprio 1
    s_cmp_lt_u32 s58, 2048
    s_cbranch_scc1 K2_PRX
    s_setprio 0
K2_PRX:
    s_nop 1
    s_cmp_le_u32 s60, 0
    s_cbranch_scc1 K2_OOL0
K2_S0:
    v_mfma_f32_32x32x8_bf16 v[104:119], v[8:9], v[14:15], v[32:47]
    v_exp_f32 v64, v88
    v_exp_f32 v65, v89
    v_exp_f32 v66, v90
    v_exp_f32 v67, v91
    v_exp_f32 v68, v92
    v_exp_f32 v69, v93
    v_exp_f32 v70, v94
    v_exp_f32 v71, v95
    s_nop 0
    v_pk_add_f32 v[56:57], v[64:65], s[66:67]
    v_pk_add_f32 v[58:59], v[66:67], s[66:67]
    v_pk_add_f32 v[60:61], v[68:69], s[66:67]
    v_pk_add_f32 v[62:63], v[70:71], s[66:67]
    s_cmp_le_u32 s60, 1
    s_cbranch_scc1 K2_OOL1
K2_S1:
    s_waitcnt vmcnt(3)
    v_mfma_f32_4x4x4_16b_bf16 v[104:107], v[6:7], v[80:81], v[104:107]
    v_exp_f32 v64, v96
    v_mfma_f32_4x4x4_16b_bf16 v[108:111], v[6:7], v[82:83], v[108:111]
    v_exp_f32 v65, v97
    v_mfma_f32_4x4x4_16b_bf16 v[112:115], v[6:7], v[84:85], v[112:115]
    v_exp_f32 v66, v98
    v_mfma_f32_4x4x4_16b_bf16 v[116:119], v[6:7], v[86:87], v[116:119]
    v_exp_f32 v67, v99
    s_waitcnt lgkmcnt(0)
    s_cmp_gt_u32 s59, 6
    s_cselect_b32 s30, 10000, 0
    buffer_load_dwordx4 v[80:83], v[20:21], s[28:31], 0 idxen offen
    buffer_load_dwordx4 v[84:87], v[22:23], s[28:31], 0 idxen offen
    v_exp_f32 v68, v100
    v_exp_f32 v69, v101
    v_exp_f32 v70, v102
    v_exp_f32 v71, v103
    v_lshlrev_b64 v[14:15], v24, v[12:13]
    ds_read_u16 v16, v25 offset:256
    ds_read_u16 v18, v25 offset:288
    ds_read_u16 v12, v26 offset:192
    v_pk_fma_f32 v[96:97], v[96:97], v[56:57], v[88:89]
    v_pk_fma_f32 v[98:99], v[98:99], v[58:59], v[90:91]
    v_pk_fma_f32 v[100:101], v[100:101], v[60:61], v[92:93]
    v_pk_fma_f32 v[102:103], v[102:103], v[62:63], v[94:95]
    v_pk_fma_f32 v[48:49], v[88:89], v[64:65], v[96:97]
    v_pk_fma_f32 v[50:51], v[90:91], v[66:67], v[98:99]
    v_pk_fma_f32 v[52:53], v[92:93], v[68:69], v[100:101]
    v_pk_fma_f32 v[54:55], v[94:95], v[70:71], v[102:103]
    v_pk_fma_f32 v[56:57], v[56:57], v[64:65], v[56:57]
    v_pk_fma_f32 v[58:59], v[58:59], v[66:67], v[58:59]
    v_pk_fma_f32 v[60:61], v[60:61], v[68:69], v[60:61]
    v_pk_fma_f32 v[62:63], v[62:63], v[70:71], v[62:63]
    s_cmp_le_u32 s60, 2
    s_cbranch_scc1 K2_OOL2
K2_S2:
    v_mfma_f32_32x32x8_bf16 v[88:103], v[8:9], v[14:15], v[32:47]
    v_exp_f32 v64, v104
    v_exp_f32 v65, v105
    v_exp_f32 v66, v106
    v_exp_f32 v67, v107
    v_exp_f32 v68, v108
    v_exp_f32 v69, v109
    v_exp_f32 v70, v110
    v_exp_f32 v71, v111
    v_pk_fma_f32 v[104:105], v[104:105], v[56:57], v[48:49]
    v_pk_fma_f32 v[106:107], v[106:107], v[58:59], v[50:51]
    v_pk_fma_f32 v[108:109], v[108:109], v[60:61], v[52:53]
    v_pk_fma_f32 v[110:111], v[110:111], v[62:63], v[54:55]
    v_pk_fma_f32 v[48:49], v[48:49], v[64:65], v[104:105]
    v_pk_fma_f32 v[50:51], v[50:51], v[66:67], v[106:107]
    v_pk_fma_f32 v[52:53], v[52:53], v[68:69], v[108:109]
    v_pk_fma_f32 v[54:55], v[54:55], v[70:71], v[110:111]
    v_pk_fma_f32 v[56:57], v[56:57], v[64:65], v[56:57]
    v_pk_fma_f32 v[58:59], v[58:59], v[66:67], v[58:59]
    v_pk_fma_f32 v[60:61], v[60:61], v[68:69], v[60:61]
    v_pk_fma_f32 v[62:63], v[62:63], v[70:71], v[62:63]
    s_cmp_le_u32 s60, 3
    s_cbranch_scc1 K2_OOL3
K2_S3:
    s_waitcnt vmcnt(2)
    v_mfma_f32_4x4x4_16b_bf16 v[88:91], v[6:7], v[72:73], v[88:91]
    v_exp_f32 v64, v112
    v_mfma_f32_4x4x4_16b_bf16 v[92:95], v[6:7], v[74:75], v[92:95]
    v_exp_f32 v65, v113
    v_mfma_f32_4x4x4_16b_bf16 v[96:99], v[6:7], v[76:77], v[96:99]
    v_exp_f32 v66, v114
    v_mfma_f32_4x4x4_16b_bf16 v[100:103], v[6:7], v[78:79], v[100:103]
    v_exp_f32 v67, v115
    s_waitcnt lgkmcnt(0)
    s_cmp_gt_u32 s59, 8
    s_cselect_b32 s30, 10000, 0
    buffer_load_dwordx4 v[72:75], v[16:17], s[28:31], 0 idxen offen
    buffer_load_dwordx4 v[76:79], v[18:19], s[28:31], 0 idxen offen
    v_exp_f32 v68, v116
    v_exp_f32 v69, v117
    v_exp_f32 v70, v118
    v_exp_f32 v71, v119
    v_lshlrev_b64 v[14:15], v24, v[12:13]
    ds_read_u16 v20, v25 offset:320
    ds_read_u16 v22, v25 offset:352
    ds_read_u16 v12, v26 offset:256
    v_pk_fma_f32 v[112:113], v[112:113], v[56:57], v[48:49]
    v_pk_fma_f32 v[114:115], v[114:115], v[58:59], v[50:51]
    v_pk_fma_f32 v[116:117], v[116:117], v[60:61], v[52:53]
    v_pk_fma_f32 v[118:119], v[118:119], v[62:63], v[54:55]
    v_pk_fma_f32 v[48:49], v[48:49], v[64:65], v[112:113]
    v_pk_fma_f32 v[50:51], v[50:51], v[66:67], v[114:115]
    v_pk_fma_f32 v[52:53], v[52:53], v[68:69], v[116:117]
    v_pk_fma_f32 v[54:55], v[54:55], v[70:71], v[118:119]
    v_pk_fma_f32 v[56:57], v[56:57], v[64:65], v[56:57]
    v_pk_fma_f32 v[58:59], v[58:59], v[66:67], v[58:59]
    v_pk_fma_f32 v[60:61], v[60:61], v[68:69], v[60:61]
    v_pk_fma_f32 v[62:63], v[62:63], v[70:71], v[62:63]
    s_cmp_le_u32 s60, 4
    s_cbranch_scc1 K2_OOL4
K2_S4:
    v_mfma_f32_32x32x8_bf16 v[104:119], v[8:9], v[14:15], v[32:47]
    v_exp_f32 v64, v88
    v_exp_f32 v65, v89
    v_exp_f32 v66, v90
    v_exp_f32 v67, v91
    v_exp_f32 v68, v92
    v_exp_f32 v69, v93
    v_exp_f32 v70, v94
    v_exp_f32 v71, v95
    v_pk_fma_f32 v[88:89], v[88:89], v[56:57], v[48:49]
    v_pk_fma_f32 v[90:91], v[90:91], v[58:59], v[50:51]
    v_pk_fma_f32 v[92:93], v[92:93], v[60:61], v[52:53]
    v_pk_fma_f32 v[94:95], v[94:95], v[62:63], v[54:55]
    v_pk_fma_f32 v[48:49], v[48:49], v[64:65], v[88:89]
    v_pk_fma_f32 v[50:51], v[50:51], v[66:67], v[90:91]
    v_pk_fma_f32 v[52:53], v[52:53], v[68:69], v[92:93]
    v_pk_fma_f32 v[54:55], v[54:55], v[70:71], v[94:95]
    v_pk_fma_f32 v[56:57], v[56:57], v[64:65], v[56:57]
    v_pk_fma_f32 v[58:59], v[58:59], v[66:67], v[58:59]
    v_pk_fma_f32 v[60:61], v[60:61], v[68:69], v[60:61]
    v_pk_fma_f32 v[62:63], v[62:63], v[70:71], v[62:63]
    s_cmp_le_u32 s60, 5
    s_cbranch_scc1 K2_OOL5
K2_S5:
    s_waitcnt vmcnt(2)
    v_mfma_f32_4x4x4_16b_bf16 v[104:107], v[6:7], v[80:81], v[104:107]
    v_exp_f32 v64, v96
    v_mfma_f32_4x4x4_16b_bf16 v[108:111], v[6:7], v[82:83], v[108:111]
    v_exp_f32 v65, v97
    v_mfma_f32_4x4x4_16b_bf16 v[112:115], v[6:7], v[84:85], v[112:115]
    v_exp_f32 v66, v98
    v_mfma_f32_4x4x4_16b_bf16 v[116:119], v[6:7], v[86:87], v[116:119]
    v_exp_f32 v67, v99
    s_waitcnt lgkmcnt(0)
    s_cmp_gt_u32 s59, 10
    s_cselect_b32 s30, 10000, 0
    buffer_load_dwordx4 v[80:83], v[20:21], s[28:31], 0 idxen offen
    buffer_load_dwordx4 v[84:87], v[22:23], s[28:31], 0 idxen offen
    v_exp_f32 v68, v100
    v_exp_f32 v69, v101
    v_exp_f32 v70, v102
    v_exp_f32 v71, v103
    v_lshlrev_b64 v[14:15], v24, v[12:13]
    ds_read_u16 v16, v25 offset:384
    ds_read_u16 v18, v25 offset:416
    ds_read_u16 v12, v26 offset:320
    v_pk_fma_f32 v[96:97], v[96:97], v[56:57], v[48:49]
    v_pk_fma_f32 v[98:99], v[98:99], v[58:59], v[50:51]
    v_pk_fma_f32 v[100:101], v[100:101], v[60:61], v[52:53]
    v_pk_fma_f32 v[102:103], v[102:103], v[62:63], v[54:55]
    v_pk_fma_f32 v[48:49], v[48:49], v[64:65], v[96:97]
    v_pk_fma_f32 v[50:51], v[50:51], v[66:67], v[98:99]
    v_pk_fma_f32 v[52:53], v[52:53], v[68:69], v[100:101]
    v_pk_fma_f32 v[54:55], v[54:55], v[70:71], v[102:103]
    v_pk_fma_f32 v[56:57], v[56:57], v[64:65], v[56:57]
    v_pk_fma_f32 v[58:59], v[58:59], v[66:67], v[58:59]
    v_pk_fma_f32 v[60:61], v[60:61], v[68:69], v[60:61]
    v_pk_fma_f32 v[62:63], v[62:63], v[70:71], v[62:63]
    s_cmp_le_u32 s60, 6
    s_cbranch_scc1 K2_OOL6
K2_S6:
    v_mfma_f32_32x32x8_bf16 v[88:103], v[8:9], v[14:15], v[32:47]
    v_exp_f32 v64, v104
    v_exp_f32 v65, v105
    v_exp_f32 v66, v106
    v_exp_f32 v67, v107
    v_exp_f32 v68, v108
    v_exp_f32 v69, v109
    v_exp_f32 v70, v110
    v_exp_f32 v71, v111
    v_pk_fma_f32 v[104:105], v[104:105], v[56:57], v[48:49]
    v_pk_fma_f32 v[106:107], v[106:107], v[58:59], v[50:51]
    v_pk_fma_f32 v[108:109], v[108:109], v[60:61], v[52:53]
    v_pk_fma_f32 v[110:111], v[110:111], v[62:63], v[54:55]
    v_pk_fma_f32 v[48:49], v[48:49], v[64:65], v[104:105]
    v_pk_fma_f32 v[50:51], v[50:51], v[66:67], v[106:107]
    v_pk_fma_f32 v[52:53], v[52:53], v[68:69], v[108:109]
    v_pk_fma_f32 v[54:55], v[54:55], v[70:71], v[110:111]
    v_pk_fma_f32 v[56:57], v[56:57], v[64:65], v[56:57]
    v_pk_fma_f32 v[58:59], v[58:59], v[66:67], v[58:59]
    v_pk_fma_f32 v[60:61], v[60:61], v[68:69], v[60:61]
    v_pk_fma_f32 v[62:63], v[62:63], v[70:71], v[62:63]
    s_cmp_le_u32 s60, 7
    s_cbranch_scc1 K2_OOL7
K2_S7:
    s_waitcnt vmcnt(2)
    v_mfma_f32_4x4x4_16b_bf16 v[88:91], v[6:7], v[72:73], v[88:91]
    v_exp_f32 v64, v112
    v_mfma_f32_4x4x4_16b_bf16 v[92:95], v[6:7], v[74:75], v[92:95]
    v_exp_f32 v65, v113
    v_mfma_f32_4x4x4_16b_bf16 v[96:99], v[6:7], v[76:77], v[96:99]
    v_exp_f32 v66, v114
    v_mfma_f32_4x4x4_16b_bf16 v[100:103], v[6:7], v[78:79], v[100:103]
    v_exp_f32 v67, v115
    s_waitcnt lgkmcnt(0)
    s_cmp_gt_u32 s59, 12
    s_cselect_b32 s30, 10000, 0
    buffer_load_dwordx4 v[72:75], v[16:17], s[28:31], 0 idxen offen
    buffer_load_dwordx4 v[76:79], v[18:19], s[28:31], 0 idxen offen
    v_exp_f32 v68, v116
    v_exp_f32 v69, v117
    v_exp_f32 v70, v118
    v_exp_f32 v71, v119
    v_lshlrev_b64 v[14:15], v24, v[12:13]
    ds_read_u16 v20, v25 offset:448
    ds_read_u16 v22, v25 offset:480
    ds_read_u16 v12, v26 offset:384
    v_pk_fma_f32 v[112:113], v[112:113], v[56:57], v[48:49]
    v_pk_fma_f32 v[114:115], v[114:115], v[58:59], v[50:51]
    v_pk_fma_f32 v[116:117], v[116:117], v[60:61], v[52:53]
    v_pk_fma_f32 v[118:119], v[118:119], v[62:63], v[54:55]
    v_pk_fma_f32 v[48:49], v[48:49], v[64:65], v[112:113]
    v_pk_fma_f32 v[50:51], v[50:51], v[66:67], v[114:115]
    v_pk_fma_f32 v[52:53], v[52:53], v[68:69], v[116:117]
    v_pk_fma_f32 v[54:55], v[54:55], v[70:71], v[118:119]
    v_pk_fma_f32 v[56:57], v[56:57], v[64:65], v[56:57]
    v_pk_fma_f32 v[58:59], v[58:59], v[66:67], v[58:59]
    v_pk_fma_f32 v[60:61], v[60:61], v[68:69], v[60:61]
    v_pk_fma_f32 v[62:63], v[62:63], v[70:71], v[62:63]
    s_cmp_le_u32 s60, 8
    s_cbranch_scc1 K2_OOL8
K2_S8:
    v_mfma_f32_32x32x8_bf16 v[104:119], v[8:9], v[14:15], v[32:47]
    v_exp_f32 v64, v88
    v_exp_f32 v65, v89
    v_exp_f32 v66, v90
    v_exp_f32 v67, v91
    v_exp_f32 v68, v92
    v_exp_f32 v69, v93
    v_exp_f32 v70, v94
    v_exp_f32 v71, v95
    v_pk_fma_f32 v[88:89], v[88:89], v[56:57], v[48:49]
    v_pk_fma_f32 v[90:91], v[90:91], v[58:59], v[50:51]
    v_pk_fma_f32 v[92:93], v[92:93], v[60:61], v[52:53]
    v_pk_fma_f32 v[94:95], v[94:95], v[62:63], v[54:55]
    v_pk_fma_f32 v[48:49], v[48:49], v[64:65], v[88:89]
    v_pk_fma_f32 v[50:51], v[50:51], v[66:67], v[90:91]
    v_pk_fma_f32 v[52:53], v[52:53], v[68:69], v[92:93]
    v_pk_fma_f32 v[54:55], v[54:55], v[70:71], v[94:95]
    v_pk_fma_f32 v[56:57], v[56:57], v[64:65], v[56:57]
    v_pk_fma_f32 v[58:59], v[58:59], v[66:67], v[58:59]
    v_pk_fma_f32 v[60:61], v[60:61], v[68:69], v[60:61]
    v_pk_fma_f32 v[62:63], v[62:63], v[70:71], v[62:63]
    s_cmp_le_u32 s60, 9
    s_cbranch_scc1 K2_OOL9
K2_S9:
    s_waitcnt vmcnt(2)
    v_mfma_f32_4x4x4_16b_bf16 v[104:107], v[6:7], v[80:81], v[104:107]
    v_exp_f32 v64, v96
    v_mfma_f32_4x4x4_16b_bf16 v[108:111], v[6:7], v[82:83], v[108:111]
    v_exp_f32 v65, v97
    v_mfma_f32_4x4x4_16b_bf16 v[112:115], v[6:7], v[84:85], v[112:115]
    v_exp_f32 v66, v98
    v_mfma_f32_4x4x4_16b_bf16 v[116:119], v[6:7], v[86:87], v[116:119]
    v_exp_f32 v67, v99
    s_waitcnt lgkmcnt(0)
    s_cmp_gt_u32 s59, 14
    s_cselect_b32 s30, 10000, 0
    buffer_load_dwordx4 v[80:83], v[20:21], s[28:31], 0 idxen offen
    buffer_load_dwordx4 v[84:87], v[22:23], s[28:31], 0 idxen offen
    v_exp_f32 v68, v100
    v_exp_f32 v69, v101
    v_exp_f32 v70, v102
    v_exp_f32 v71, v103
    v_lshlrev_b64 v[14:15], v24, v[12:13]
    ds_read_u16 v16, v25 offset:512
    ds_read_u16 v18, v25 offset:544
    ds_read_u16 v12, v26 offset:448
    v_pk_fma_f32 v[96:97], v[96:97], v[56:57], v[48:49]
    v_pk_fma_f32 v[98:99], v[98:99], v[58:59], v[50:51]
    v_pk_fma_f32 v[100:101], v[100:101], v[60:61], v[52:53]
    v_pk_fma_f32 v[102:103], v[102:103], v[62:63], v[54:55]
    v_pk_fma_f32 v[48:49], v[48:49], v[64:65], v[96:97]
    v_pk_fma_f32 v[50:51], v[50:51], v[66:67], v[98:99]
    v_pk_fma_f32 v[52:53], v[52:53], v[68:69], v[100:101]
    v_pk_fma_f32 v[54:55], v[54:55], v[70:71], v[102:103]
    v_pk_fma_f32 v[56:57], v[56:57], v[64:65], v[56:57]
    v_pk_fma_f32 v[58:59], v[58:59], v[66:67], v[58:59]
    v_pk_fma_f32 v[60:61], v[60:61], v[68:69], v[60:61]
    v_pk_fma_f32 v[62:63], v[62:63], v[70:71], v[62:63]
    s_cmp_le_u32 s60, 10
    s_cbranch_scc1 K2_OOL10
K2_S10:
    v_mfma_f32_32x32x8_bf16 v[88:103], v[8:9], v[14:15], v[32:47]
    v_exp_f32 v64, v104
    v_exp_f32 v65, v105
    v_exp_f32 v66, v106
    v_exp_f32 v67, v107
    v_exp_f32 v68, v108
    v_exp_f32 v69, v109
    v_exp_f32 v70, v110
    v_exp_f32 v71, v111
    v_pk_fma_f32 v[104:105], v[104:105], v[56:57], v[48:49]
    v_pk_fma_f32 v[106:107], v[106:107], v[58:59], v[50:51]
    v_pk_fma_f32 v[108:109], v[108:109], v[60:61], v[52:53]
    v_pk_fma_f32 v[110:111], v[110:111], v[62:63], v[54:55]
    v_pk_fma_f32 v[48:49], v[48:49], v[64:65], v[104:105]
    v_pk_fma_f32 v[50:51], v[50:51], v[66:67], v[106:107]
    v_pk_fma_f32 v[52:53], v[52:53], v[68:69], v[108:109]
    v_pk_fma_f32 v[54:55], v[54:55], v[70:71], v[110:111]
    v_pk_fma_f32 v[56:57], v[56:57], v[64:65], v[56:57]
    v_pk_fma_f32 v[58:59], v[58:59], v[66:67], v[58:59]
    v_pk_fma_f32 v[60:61], v[60:61], v[68:69], v[60:61]
    v_pk_fma_f32 v[62:63], v[62:63], v[70:71], v[62:63]
    s_cmp_le_u32 s60, 11
    s_cbranch_scc1 K2_OOL11
K2_S11:
    s_waitcnt vmcnt(2)
    v_mfma_f32_4x4x4_16b_bf16 v[88:91], v[6:7], v[72:73], v[88:91]
    v_exp_f32 v64, v112
    v_mfma_f32_4x4x4_16b_bf16 v[92:95], v[6:7], v[74:75], v[92:95]
    v_exp_f32 v65, v113
    v_mfma_f32_4x4x4_16b_bf16 v[96:99], v[6:7], v[76:77], v[96:99]
    v_exp_f32 v66, v114
    v_mfma_f32_4x4x4_16b_bf16 v[100:103], v[6:7], v[78:79], v[100:103]
    v_exp_f32 v67, v115
    s_waitcnt lgkmcnt(0)
    s_cmp_gt_u32 s59, 16
    s_cselect_b32 s30, 10000, 0
    buffer_load_dwordx4 v[72:75], v[16:17], s[28:31], 0 idxen offen
    buffer_load_dwordx4 v[76:79], v[18:19], s[28:31], 0 idxen offen
    v_exp_f32 v68, v116
    v_exp_f32 v69, v117
    v_exp_f32 v70, v118
    v_exp_f32 v71, v119
    v_lshlrev_b64 v[14:15], v24, v[12:13]
    ds_read_u16 v20, v25 offset:576
    ds_read_u16 v22, v25 offset:608
    ds_read_u16 v12, v26 offset:512
    v_pk_fma_f32 v[112:113], v[112:113], v[56:57], v[48:49]
    v_pk_fma_f32 v[114:115], v[114:115], v[58:59], v[50:51]
    v_pk_fma_f32 v[116:117], v[116:117], v[60:61], v[52:53]
    v_pk_fma_f32 v[118:119], v[118:119], v[62:63], v[54:55]
    v_pk_fma_f32 v[48:49], v[48:49], v[64:65], v[112:113]
    v_pk_fma_f32 v[50:51], v[50:51], v[66:67], v[114:115]
    v_pk_fma_f32 v[52:53], v[52:53], v[68:69], v[116:117]
    v_pk_fma_f32 v[54:55], v[54:55], v[70:71], v[118:119]
    v_pk_fma_f32 v[56:57], v[56:57], v[64:65], v[56:57]
    v_pk_fma_f32 v[58:59], v[58:59], v[66:67], v[58:59]
    v_pk_fma_f32 v[60:61], v[60:61], v[68:69], v[60:61]
    v_pk_fma_f32 v[62:63], v[62:63], v[70:71], v[62:63]
    s_cmp_le_u32 s60, 12
    s_cbranch_scc1 K2_OOL12
K2_S12:
    v_mfma_f32_32x32x8_bf16 v[104:119], v[8:9], v[14:15], v[32:47]
    v_exp_f32 v64, v88
    v_exp_f32 v65, v89
    v_exp_f32 v66, v90
    v_exp_f32 v67, v91
    v_exp_f32 v68, v92
    v_exp_f32 v69, v93
    v_exp_f32 v70, v94
    v_exp_f32 v71, v95
    v_pk_fma_f32 v[88:89], v[88:89], v[56:57], v[48:49]
    v_pk_fma_f32 v[90:91], v[90:91], v[58:59], v[50:51]
    v_pk_fma_f32 v[92:93], v[92:93], v[60:61], v[52:53]
    v_pk_fma_f32 v[94:95], v[94:95], v[62:63], v[54:55]
    v_pk_fma_f32 v[48:49], v[48:49], v[64:65], v[88:89]
    v_pk_fma_f32 v[50:51], v[50:51], v[66:67], v[90:91]
    v_pk_fma_f32 v[52:53], v[52:53], v[68:69], v[92:93]
    v_pk_fma_f32 v[54:55], v[54:55], v[70:71], v[94:95]
    v_pk_fma_f32 v[56:57], v[56:57], v[64:65], v[56:57]
    v_pk_fma_f32 v[58:59], v[58:59], v[66:67], v[58:59]
    v_pk_fma_f32 v[60:61], v[60:61], v[68:69], v[60:61]
    v_pk_fma_f32 v[62:63], v[62:63], v[70:71], v[62:63]
    s_cmp_le_u32 s60, 13
    s_cbranch_scc1 K2_OOL13
K2_S13:
    s_waitcnt vmcnt(2)
    v_mfma_f32_4x4x4_16b_bf16 v[104:107], v[6:7], v[80:81], v[104:107]
    v_exp_f32 v64, v96
    v_mfma_f32_4x4x4_16b_bf16 v[108:111], v[6:7], v[82:83], v[108:111]
    v_exp_f32 v65, v97
    v_mfma_f32_4x4x4_16b_bf16 v[112:115], v[6:7], v[84:85], v[112:115]
    v_exp_f32 v66, v98
    v_mfma_f32_4x4x4_16b_bf16 v[116:119], v[6:7], v[86:87], v[116:119]
    v_exp_f32 v67, v99
    s_waitcnt lgkmcnt(0)
    s_cmp_gt_u32 s59, 18
    s_cselect_b32 s30, 10000, 0
    buffer_load_dwordx4 v[80:83], v[20:21], s[28:31], 0 idxen offen
    buffer_load_dwordx4 v[84:87], v[22:23], s[28:31], 0 idxen offen
    v_exp_f32 v68, v100
    v_exp_f32 v69, v101
    v_exp_f32 v70, v102
    v_exp_f32 v71, v103
    v_lshlrev_b64 v[14:15], v24, v[12:13]
    ds_read_u16 v16, v25 offset:640
    ds_read_u16 v18, v25 offset:672
    ds_read_u16 v12, v26 offset:576
    v_pk_fma_f32 v[96:97], v[96:97], v[56:57], v[48:49]
    v_pk_fma_f32 v[98:99], v[98:99], v[58:59], v[50:51]
    v_pk_fma_f32 v[100:101], v[100:101], v[60:61], v[52:53]
    v_pk_fma_f32 v[102:103], v[102:103], v[62:63], v[54:55]
    v_pk_fma_f32 v[48:49], v[48:49], v[64:65], v[96:97]
    v_pk_fma_f32 v[50:51], v[50:51], v[66:67], v[98:99]
    v_pk_fma_f32 v[52:53], v[52:53], v[68:69], v[100:101]
    v_pk_fma_f32 v[54:55], v[54:55], v[70:71], v[102:103]
    v_pk_fma_f32 v[56:57], v[56:57], v[64:65], v[56:57]
    v_pk_fma_f32 v[58:59], v[58:59], v[66:67], v[58:59]
    v_pk_fma_f32 v[60:61], v[60:61], v[68:69], v[60:61]
    v_pk_fma_f32 v[62:63], v[62:63], v[70:71], v[62:63]
    s_cmp_le_u32 s60, 14
    s_cbranch_scc1 K2_OOL14
K2_S14:
    v_mfma_f32_32x32x8_bf16 v[88:103], v[8:9], v[14:15], v[32:47]
    v_exp_f32 v64, v104
    v_exp_f32 v65, v105
    v_exp_f32 v66, v106
    v_exp_f32 v67, v107
    v_exp_f32 v68, v108
    v_exp_f32 v69, v109
    v_exp_f32 v70, v110
    v_exp_f32 v71, v111
    v_pk_fma_f32 v[104:105], v[104:105], v[56:57], v[48:49]
    v_pk_fma_f32 v[106:107], v[106:107], v[58:59], v[50:51]
    v_pk_fma_f32 v[108:109], v[108:109], v[60:61], v[52:53]
    v_pk_fma_f32 v[110:111], v[110:111], v[62:63], v[54:55]
    v_pk_fma_f32 v[48:49], v[48:49], v[64:65], v[104:105]
    v_pk_fma_f32 v[50:51], v[50:51], v[66:67], v[106:107]
    v_pk_fma_f32 v[52:53], v[52:53], v[68:69], v[108:109]
    v_pk_fma_f32 v[54:55], v[54:55], v[70:71], v[110:111]
    v_pk_fma_f32 v[56:57], v[56:57], v[64:65], v[56:57]
    v_pk_fma_f32 v[58:59], v[58:59], v[66:67], v[58:59]
    v_pk_fma_f32 v[60:61], v[60:61], v[68:69], v[60:61]
    v_pk_fma_f32 v[62:63], v[62:63], v[70:71], v[62:63]
    s_cmp_le_u32 s60, 15
    s_cbranch_scc1 K2_OOL15
K2_S15:
    s_waitcnt vmcnt(2)
    v_mfma_f32_4x4x4_16b_bf16 v[88:91], v[6:7], v[72:73], v[88:91]
    v_exp_f32 v64, v112
    v_mfma_f32_4x4x4_16b_bf16 v[92:95], v[6:7], v[74:75], v[92:95]
    v_exp_f32 v65, v113
    v_mfma_f32_4x4x4_16b_bf16 v[96:99], v[6:7], v[76:77], v[96:99]
    v_exp_f32 v66, v114
    v_mfma_f32_4x4x4_16b_bf16 v[100:103], v[6:7], v[78:79], v[100:103]
    v_exp_f32 v67, v115
    s_waitcnt lgkmcnt(0)
    s_cmp_gt_u32 s59, 20
    s_cselect_b32 s30, 10000, 0
    buffer_load_dwordx4 v[72:75], v[16:17], s[28:31], 0 idxen offen
    buffer_load_dwordx4 v[76:79], v[18:19], s[28:31], 0 idxen offen
    v_exp_f32 v68, v116
    v_exp_f32 v69, v117
    v_exp_f32 v70, v118
    v_exp_f32 v71, v119
    v_lshlrev_b64 v[14:15], v24, v[12:13]
    ds_read_u16 v20, v25 offset:704
    ds_read_u16 v22, v25 offset:736
    ds_read_u16 v12, v26 offset:640
    v_pk_fma_f32 v[112:113], v[112:113], v[56:57], v[48:49]
    v_pk_fma_f32 v[114:115], v[114:115], v[58:59], v[50:51]
    v_pk_fma_f32 v[116:117], v[116:117], v[60:61], v[52:53]
    v_pk_fma_f32 v[118:119], v[118:119], v[62:63], v[54:55]
    v_pk_fma_f32 v[48:49], v[48:49], v[64:65], v[112:113]
    v_pk_fma_f32 v[50:51], v[50:51], v[66:67], v[114:115]
    v_pk_fma_f32 v[52:53], v[52:53], v[68:69], v[116:117]
    v_pk_fma_f32 v[54:55], v[54:55], v[70:71], v[118:119]
    v_pk_fma_f32 v[56:57], v[56:57], v[64:65], v[56:57]
    v_pk_fma_f32 v[58:59], v[58:59], v[66:67], v[58:59]
    v_pk_fma_f32 v[60:61], v[60:61], v[68:69], v[60:61]
    v_pk_fma_f32 v[62:63], v[62:63], v[70:71], v[62:63]
    s_cmp_le_u32 s60, 16
    s_cbranch_scc1 K2_OOL16
K2_S16:
    v_mfma_f32_32x32x8_bf16 v[104:119], v[8:9], v[14:15], v[32:47]
    v_exp_f32 v64, v88
    v_exp_f32 v65, v89
    v_exp_f32 v66, v90
    v_exp_f32 v67, v91
    v_exp_f32 v68, v92
    v_exp_f32 v69, v93
    v_exp_f32 v70, v94
    v_exp_f32 v71, v95
    v_pk_fma_f32 v[88:89], v[88:89], v[56:57], v[48:49]
    v_pk_fma_f32 v[90:91], v[90:91], v[58:59], v[50:51]
    v_pk_fma_f32 v[92:93], v[92:93], v[60:61], v[52:53]
    v_pk_fma_f32 v[94:95], v[94:95], v[62:63], v[54:55]
    v_pk_fma_f32 v[48:49], v[48:49], v[64:65], v[88:89]
    v_pk_fma_f32 v[50:51], v[50:51], v[66:67], v[90:91]
    v_pk_fma_f32 v[52:53], v[52:53], v[68:69], v[92:93]
    v_pk_fma_f32 v[54:55], v[54:55], v[70:71], v[94:95]
    v_pk_fma_f32 v[56:57], v[56:57], v[64:65], v[56:57]
    v_pk_fma_f32 v[58:59], v[58:59], v[66:67], v[58:59]
    v_pk_fma_f32 v[60:61], v[60:61], v[68:69], v[60:61]
    v_pk_fma_f32 v[62:63], v[62:63], v[70:71], v[62:63]
    s_cmp_le_u32 s60, 17
    s_cbranch_scc1 K2_OOL17
K2_S17:
    s_waitcnt vmcnt(2)
    v_mfma_f32_4x4x4_16b_bf16 v[104:107], v[6:7], v[80:81], v[104:107]
    v_exp_f32 v64, v96
    v_mfma_f32_4x4x4_16b_bf16 v[108:111], v[6:7], v[82:83], v[108:111]
    v_exp_f32 v65, v97
    v_mfma_f32_4x4x4_16b_bf16 v[112:115], v[6:7], v[84:85], v[112:115]
    v_exp_f32 v66, v98
    v_mfma_f32_4x4x4_16b_bf16 v[116:119], v[6:7], v[86:87], v[116:119]
    v_exp_f32 v67, v99
    s_waitcnt lgkmcnt(0)
    s_cmp_gt_u32 s59, 22
    s_cselect_b32 s30, 10000, 0
    buffer_load_dwordx4 v[80:83], v[20:21], s[28:31], 0 idxen offen
    buffer_load_dwordx4 v[84:87], v[22:23], s[28:31], 0 idxen offen
    v_exp_f32 v68, v100
    v_exp_f32 v69, v101
    v_exp_f32 v70, v102
    v_exp_f32 v71, v103
    v_lshlrev_b64 v[14:15], v24, v[12:13]
    ds_read_u16 v16, v25 offset:768
    ds_read_u16 v18, v25 offset:800
    ds_read_u16 v12, v26 offset:704
    v_pk_fma_f32 v[96:97], v[96:97], v[56:57], v[48:49]
    v_pk_fma_f32 v[98:99], v[98:99], v[58:59], v[50:51]
    v_pk_fma_f32 v[100:101], v[100:101], v[60:61], v[52:53]
    v_pk_fma_f32 v[102:103], v[102:103], v[62:63], v[54:55]
    v_pk_fma_f32 v[48:49], v[48:49], v[64:65], v[96:97]
    v_pk_fma_f32 v[50:51], v[50:51], v[66:67], v[98:99]
    v_pk_fma_f32 v[52:53], v[52:53], v[68:69], v[100:101]
    v_pk_fma_f32 v[54:55], v[54:55], v[70:71], v[102:103]
    v_pk_fma_f32 v[56:57], v[56:57], v[64:65], v[56:57]
    v_pk_fma_f32 v[58:59], v[58:59], v[66:67], v[58:59]
    v_pk_fma_f32 v[60:61], v[60:61], v[68:69], v[60:61]
    v_pk_fma_f32 v[62:63], v[62:63], v[70:71], v[62:63]
    s_cmp_le_u32 s60, 18
    s_cbranch_scc1 K2_OOL18
K2_S18:
    v_mfma_f32_32x32x8_bf16 v[88:103], v[8:9], v[14:15], v[32:47]
    v_exp_f32 v64, v104
    v_exp_f32 v65, v105
    v_exp_f32 v66, v106
    v_exp_f32 v67, v107
    v_exp_f32 v68, v108
    v_exp_f32 v69, v109
    v_exp_f32 v70, v110
    v_exp_f32 v71, v111
    v_pk_fma_f32 v[104:105], v[104:105], v[56:57], v[48:49]
    v_pk_fma_f32 v[106:107], v[106:107], v[58:59], v[50:51]
    v_pk_fma_f32 v[108:109], v[108:109], v[60:61], v[52:53]
    v_pk_fma_f32 v[110:111], v[110:111], v[62:63], v[54:55]
    v_pk_fma_f32 v[48:49], v[48:49], v[64:65], v[104:105]
    v_pk_fma_f32 v[50:51], v[50:51], v[66:67], v[106:107]
    v_pk_fma_f32 v[52:53], v[52:53], v[68:69], v[108:109]
    v_pk_fma_f32 v[54:55], v[54:55], v[70:71], v[110:111]
    v_pk_fma_f32 v[56:57], v[56:57], v[64:65], v[56:57]
    v_pk_fma_f32 v[58:59], v[58:59], v[66:67], v[58:59]
    v_pk_fma_f32 v[60:61], v[60:61], v[68:69], v[60:61]
    v_pk_fma_f32 v[62:63], v[62:63], v[70:71], v[62:63]
    s_cmp_le_u32 s60, 19
    s_cbranch_scc1 K2_OOL19
K2_S19:
    s_waitcnt vmcnt(2)
    v_mfma_f32_4x4x4_16b_bf16 v[88:91], v[6:7], v[72:73], v[88:91]
    v_exp_f32 v64, v112
    v_mfma_f32_4x4x4_16b_bf16 v[92:95], v[6:7], v[74:75], v[92:95]
    v_exp_f32 v65, v113
    v_mfma_f32_4x4x4_16b_bf16 v[96:99], v[6:7], v[76:77], v[96:99]
    v_exp_f32 v66, v114
    v_mfma_f32_4x4x4_16b_bf16 v[100:103], v[6:7], v[78:79], v[100:103]
    v_exp_f32 v67, v115
    s_waitcnt lgkmcnt(0)
    s_cmp_gt_u32 s59, 24
    s_cselect_b32 s30, 10000, 0
    buffer_load_dwordx4 v[72:75], v[16:17], s[28:31], 0 idxen offen
    buffer_load_dwordx4 v[76:79], v[18:19], s[28:31], 0 idxen offen
    v_exp_f32 v68, v116
    v_exp_f32 v69, v117
    v_exp_f32 v70, v118
    v_exp_f32 v71, v119
    v_lshlrev_b64 v[14:15], v24, v[12:13]
    ds_read_u16 v20, v25 offset:832
    ds_read_u16 v22, v25 offset:864
    ds_read_u16 v12, v26 offset:768
    v_pk_fma_f32 v[112:113], v[112:113], v[56:57], v[48:49]
    v_pk_fma_f32 v[114:115], v[114:115], v[58:59], v[50:51]
    v_pk_fma_f32 v[116:117], v[116:117], v[60:61], v[52:53]
    v_pk_fma_f32 v[118:119], v[118:119], v[62:63], v[54:55]
    v_pk_fma_f32 v[48:49], v[48:49], v[64:65], v[112:113]
    v_pk_fma_f32 v[50:51], v[50:51], v[66:67], v[114:115]
    v_pk_fma_f32 v[52:53], v[52:53], v[68:69], v[116:117]
    v_pk_fma_f32 v[54:55], v[54:55], v[70:71], v[118:119]
    v_pk_fma_f32 v[56:57], v[56:57], v[64:65], v[56:57]
    v_pk_fma_f32 v[58:59], v[58:59], v[66:67], v[58:59]
    v_pk_fma_f32 v[60:61], v[60:61], v[68:69], v[60:61]
    v_pk_fma_f32 v[62:63], v[62:63], v[70:71], v[62:63]
    s_cmp_le_u32 s60, 20
    s_cbranch_scc1 K2_OOL20
K2_S20:
    v_mfma_f32_32x32x8_bf16 v[104:119], v[8:9], v[14:15], v[32:47]
    v_exp_f32 v64, v88
    v_exp_f32 v65, v89
    v_exp_f32 v66, v90
    v_exp_f32 v67, v91
    v_exp_f32 v68, v92
    v_exp_f32 v69, v93
    v_exp_f32 v70, v94
    v_exp_f32 v71, v95
    v_pk_fma_f32 v[88:89], v[88:89], v[56:57], v[48:49]
    v_pk_fma_f32 v[90:91], v[90:91], v[58:59], v[50:51]
    v_pk_fma_f32 v[92:93], v[92:93], v[60:61], v[52:53]
    v_pk_fma_f32 v[94:95], v[94:95], v[62:63], v[54:55]
    v_pk_fma_f32 v[48:49], v[48:49], v[64:65], v[88:89]
    v_pk_fma_f32 v[50:51], v[50:51], v[66:67], v[90:91]
    v_pk_fma_f32 v[52:53], v[52:53], v[68:69], v[92:93]
    v_pk_fma_f32 v[54:55], v[54:55], v[70:71], v[94:95]
    v_pk_fma_f32 v[56:57], v[56:57], v[64:65], v[56:57]
    v_pk_fma_f32 v[58:59], v[58:59], v[66:67], v[58:59]
    v_pk_fma_f32 v[60:61], v[60:61], v[68:69], v[60:61]
    v_pk_fma_f32 v[62:63], v[62:63], v[70:71], v[62:63]
    s_cmp_le_u32 s60, 21
    s_cbranch_scc1 K2_OOL21
K2_S21:
    s_waitcnt vmcnt(2)
    v_mfma_f32_4x4x4_16b_bf16 v[104:107], v[6:7], v[80:81], v[104:107]
    v_exp_f32 v64, v96
    v_mfma_f32_4x4x4_16b_bf16 v[108:111], v[6:7], v[82:83], v[108:111]
    v_exp_f32 v65, v97
    v_mfma_f32_4x4x4_16b_bf16 v[112:115], v[6:7], v[84:85], v[112:115]
    v_exp_f32 v66, v98
    v_mfma_f32_4x4x4_16b_bf16 v[116:119], v[6:7], v[86:87], v[116:119]
    v_exp_f32 v67, v99
    s_waitcnt lgkmcnt(0)
    s_cmp_gt_u32 s59, 26
    s_cselect_b32 s30, 10000, 0
    buffer_load_dwordx4 v[80:83], v[20:21], s[28:31], 0 idxen offen
    buffer_load_dwordx4 v[84:87], v[22:23], s[28:31], 0 idxen offen
    v_exp_f32 v68, v100
    v_exp_f32 v69, v101
    v_exp_f32 v70, v102
    v_exp_f32 v71, v103
    v_lshlrev_b64 v[14:15], v24, v[12:13]
    ds_read_u16 v16, v25 offset:896
    ds_read_u16 v18, v25 offset:928
    ds_read_u16 v12, v26 offset:832
    v_pk_fma_f32 v[96:97], v[96:97], v[56:57], v[48:49]
    v_pk_fma_f32 v[98:99], v[98:99], v[58:59], v[50:51]
    v_pk_fma_f32 v[100:101], v[100:101], v[60:61], v[52:53]
    v_pk_fma_f32 v[102:103], v[102:103], v[62:63], v[54:55]
    v_pk_fma_f32 v[48:49], v[48:49], v[64:65], v[96:97]
    v_pk_fma_f32 v[50:51], v[50:51], v[66:67], v[98:99]
    v_pk_fma_f32 v[52:53], v[52:53], v[68:69], v[100:101]
    v_pk_fma_f32 v[54:55], v[54:55], v[70:71], v[102:103]
    v_pk_fma_f32 v[56:57], v[56:57], v[64:65], v[56:57]
    v_pk_fma_f32 v[58:59], v[58:59], v[66:67], v[58:59]
    v_pk_fma_f32 v[60:61], v[60:61], v[68:69], v[60:61]
    v_pk_fma_f32 v[62:63], v[62:63], v[70:71], v[62:63]
    s_cmp_le_u32 s60, 22
    s_cbranch_scc1 K2_OOL22
K2_S22:
    v_mfma_f32_32x32x8_bf16 v[88:103], v[8:9], v[14:15], v[32:47]
    v_exp_f32 v64, v104
    v_exp_f32 v65, v105
    v_exp_f32 v66, v106
    v_exp_f32 v67, v107
    v_exp_f32 v68, v108
    v_exp_f32 v69, v109
    v_exp_f32 v70, v110
    v_exp_f32 v71, v111
    v_pk_fma_f32 v[104:105], v[104:105], v[56:57], v[48:49]
    v_pk_fma_f32 v[106:107], v[106:107], v[58:59], v[50:51]
    v_pk_fma_f32 v[108:109], v[108:109], v[60:61], v[52:53]
    v_pk_fma_f32 v[110:111], v[110:111], v[62:63], v[54:55]
    v_pk_fma_f32 v[48:49], v[48:49], v[64:65], v[104:105]
    v_pk_fma_f32 v[50:51], v[50:51], v[66:67], v[106:107]
    v_pk_fma_f32 v[52:53], v[52:53], v[68:69], v[108:109]
    v_pk_fma_f32 v[54:55], v[54:55], v[70:71], v[110:111]
    v_pk_fma_f32 v[56:57], v[56:57], v[64:65], v[56:57]
    v_pk_fma_f32 v[58:59], v[58:59], v[66:67], v[58:59]
    v_pk_fma_f32 v[60:61], v[60:61], v[68:69], v[60:61]
    v_pk_fma_f32 v[62:63], v[62:63], v[70:71], v[62:63]
    s_cmp_le_u32 s60, 23
    s_cbranch_scc1 K2_OOL23
K2_S23:
    s_waitcnt vmcnt(2)
    v_mfma_f32_4x4x4_16b_bf16 v[88:91], v[6:7], v[72:73], v[88:91]
    v_exp_f32 v64, v112
    v_mfma_f32_4x4x4_16b_bf16 v[92:95], v[6:7], v[74:75], v[92:95]
    v_exp_f32 v65, v113
    v_mfma_f32_4x4x4_16b_bf16 v[96:99], v[6:7], v[76:77], v[96:99]
    v_exp_f32 v66, v114
    v_mfma_f32_4x4x4_16b_bf16 v[100:103], v[6:7], v[78:79], v[100:103]
    v_exp_f32 v67, v115
    s_waitcnt lgkmcnt(0)
    s_cmp_gt_u32 s59, 28
    s_cselect_b32 s30, 10000, 0
    buffer_load_dwordx4 v[72:75], v[16:17], s[28:31], 0 idxen offen
    buffer_load_dwordx4 v[76:79], v[18:19], s[28:31], 0 idxen offen
    v_exp_f32 v68, v116
    v_exp_f32 v69, v117
    v_exp_f32 v70, v118
    v_exp_f32 v71, v119
    v_lshlrev_b64 v[14:15], v24, v[12:13]
    ds_read_u16 v20, v25 offset:960
    ds_read_u16 v22, v25 offset:992
    ds_read_u16 v12, v26 offset:896
    v_pk_fma_f32 v[112:113], v[112:113], v[56:57], v[48:49]
    v_pk_fma_f32 v[114:115], v[114:115], v[58:59], v[50:51]
    v_pk_fma_f32 v[116:117], v[116:117], v[60:61], v[52:53]
    v_pk_fma_f32 v[118:119], v[118:119], v[62:63], v[54:55]
    v_pk_fma_f32 v[48:49], v[48:49], v[64:65], v[112:113]
    v_pk_fma_f32 v[50:51], v[50:51], v[66:67], v[114:115]
    v_pk_fma_f32 v[52:53], v[52:53], v[68:69], v[116:117]
    v_pk_fma_f32 v[54:55], v[54:55], v[70:71], v[118:119]
    v_pk_fma_f32 v[56:57], v[56:57], v[64:65], v[56:57]
    v_pk_fma_f32 v[58:59], v[58:59], v[66:67], v[58:59]
    v_pk_fma_f32 v[60:61], v[60:61], v[68:69], v[60:61]
    v_pk_fma_f32 v[62:63], v[62:63], v[70:71], v[62:63]
    s_cmp_le_u32 s60, 24
    s_cbranch_scc1 K2_OOL24
K2_S24:
    v_mfma_f32_32x32x8_bf16 v[104:119], v[8:9], v[14:15], v[32:47]
    v_exp_f32 v64, v88
    v_exp_f32 v65, v89
    v_exp_f32 v66, v90
    v_exp_f32 v67, v91
    v_exp_f32 v68, v92
    v_exp_f32 v69, v93
    v_exp_f32 v70, v94
    v_exp_f32 v71, v95
    v_pk_fma_f32 v[88:89], v[88:89], v[56:57], v[48:49]
    v_pk_fma_f32 v[90:91], v[90:91], v[58:59], v[50:51]
    v_pk_fma_f32 v[92:93], v[92:93], v[60:61], v[52:53]
    v_pk_fma_f32 v[94:95], v[94:95], v[62:63], v[54:55]
    v_pk_fma_f32 v[48:49], v[48:49], v[64:65], v[88:89]
    v_pk_fma_f32 v[50:51], v[50:51], v[66:67], v[90:91]
    v_pk_fma_f32 v[52:53], v[52:53], v[68:69], v[92:93]
    v_pk_fma_f32 v[54:55], v[54:55], v[70:71], v[94:95]
    v_pk_fma_f32 v[56:57], v[56:57], v[64:65], v[56:57]
    v_pk_fma_f32 v[58:59], v[58:59], v[66:67], v[58:59]
    v_pk_fma_f32 v[60:61], v[60:61], v[68:69], v[60:61]
    v_pk_fma_f32 v[62:63], v[62:63], v[70:71], v[62:63]
    s_cmp_le_u32 s60, 25
    s_cbranch_scc1 K2_OOL25
K2_S25:
    s_waitcnt vmcnt(2)
    v_mfma_f32_4x4x4_16b_bf16 v[104:107], v[6:7], v[80:81], v[104:107]
    v_exp_f32 v64, v96
    v_mfma_f32_4x4x4_16b_bf16 v[108:111], v[6:7], v[82:83], v[108:111]
    v_exp_f32 v65, v97
    v_mfma_f32_4x4x4_16b_bf16 v[112:115], v[6:7], v[84:85], v[112:115]
    v_exp_f32 v66, v98
    v_mfma_f32_4x4x4_16b_bf16 v[116:119], v[6:7], v[86:87], v[116:119]
    v_exp_f32 v67, v99
    s_waitcnt lgkmcnt(0)
    s_cmp_gt_u32 s59, 30
    s_cselect_b32 s30, 10000, 0
    buffer_load_dwordx4 v[80:83], v[20:21], s[28:31], 0 idxen offen
    buffer_load_dwordx4 v[84:87], v[22:23], s[28:31], 0 idxen offen
    v_exp_f32 v68, v100
    v_exp_f32 v69, v101
    v_exp_f32 v70, v102
    v_exp_f32 v71, v103
    v_lshlrev_b64 v[14:15], v24, v[12:13]
    ds_read_u16 v16, v25 offset:1024
    ds_read_u16 v18, v25 offset:1056
    ds_read_u16 v12, v26 offset:960
    v_pk_fma_f32 v[96:97], v[96:97], v[56:57], v[48:49]
    v_pk_fma_f32 v[98:99], v[98:99], v[58:59], v[50:51]
    v_pk_fma_f32 v[100:101], v[100:101], v[60:61], v[52:53]
    v_pk_fma_f32 v[102:103], v[102:103], v[62:63], v[54:55]
    v_pk_fma_f32 v[48:49], v[48:49], v[64:65], v[96:97]
    v_pk_fma_f32 v[50:51], v[50:51], v[66:67], v[98:99]
    v_pk_fma_f32 v[52:53], v[52:53], v[68:69], v[100:101]
    v_pk_fma_f32 v[54:55], v[54:55], v[70:71], v[102:103]
    v_pk_fma_f32 v[56:57], v[56:57], v[64:65], v[56:57]
    v_pk_fma_f32 v[58:59], v[58:59], v[66:67], v[58:59]
    v_pk_fma_f32 v[60:61], v[60:61], v[68:69], v[60:61]
    v_pk_fma_f32 v[62:63], v[62:63], v[70:71], v[62:63]
    s_cmp_le_u32 s60, 26
    s_cbranch_scc1 K2_OOL26
K2_S26:
    v_mfma_f32_32x32x8_bf16 v[88:103], v[8:9], v[14:15], v[32:47]
    v_exp_f32 v64, v104
    v_exp_f32 v65, v105
    v_exp_f32 v66, v106
    v_exp_f32 v67, v107
    v_exp_f32 v68, v108
    v_exp_f32 v69, v109
    v_exp_f32 v70, v110
    v_exp_f32 v71, v111
    v_pk_fma_f32 v[104:105], v[104:105], v[56:57], v[48:49]
    v_pk_fma_f32 v[106:107], v[106:107], v[58:59], v[50:51]
    v_pk_fma_f32 v[108:109], v[108:109], v[60:61], v[52:53]
    v_pk_fma_f32 v[110:111], v[110:111], v[62:63], v[54:55]
    v_pk_fma_f32 v[48:49], v[48:49], v[64:65], v[104:105]
    v_pk_fma_f32 v[50:51], v[50:51], v[66:67], v[106:107]
    v_pk_fma_f32 v[52:53], v[52:53], v[68:69], v[108:109]
    v_pk_fma_f32 v[54:55], v[54:55], v[70:71], v[110:111]
    v_pk_fma_f32 v[56:57], v[56:57], v[64:65], v[56:57]
    v_pk_fma_f32 v[58:59], v[58:59], v[66:67], v[58:59]
    v_pk_fma_f32 v[60:61], v[60:61], v[68:69], v[60:61]
    v_pk_fma_f32 v[62:63], v[62:63], v[70:71], v[62:63]
    s_cmp_le_u32 s60, 27
    s_cbranch_scc1 K2_OOL27
K2_S27:
    s_waitcnt vmcnt(2)
    v_mfma_f32_4x4x4_16b_bf16 v[88:91], v[6:7], v[72:73], v[88:91]
    v_exp_f32 v64, v112
    v_mfma_f32_4x4x4_16b_bf16 v[92:95], v[6:7], v[74:75], v[92:95]
    v_exp_f32 v65, v113
    v_mfma_f32_4x4x4_16b_bf16 v[96:99], v[6:7], v[76:77], v[96:99]
    v_exp_f32 v66, v114
    v_mfma_f32_4x4x4_16b_bf16 v[100:103], v[6:7], v[78:79], v[100:103]
    v_exp_f32 v67, v115
    s_waitcnt lgkmcnt(0)
    s_cmp_gt_u32 s59, 32
    s_cselect_b32 s30, 10000, 0
    buffer_load_dwordx4 v[72:75], v[16:17], s[28:31], 0 idxen offen
    buffer_load_dwordx4 v[76:79], v[18:19], s[28:31], 0 idxen offen
    v_exp_f32 v68, v116
    v_exp_f32 v69, v117
    v_exp_f32 v70, v118
    v_exp_f32 v71, v119
    v_lshlrev_b64 v[14:15], v24, v[12:13]
    ds_read_u16 v20, v25 offset:1088
    ds_read_u16 v22, v25 offset:1120
    ds_read_u16 v12, v26 offset:1024
    v_pk_fma_f32 v[112:113], v[112:113], v[56:57], v[48:49]
    v_pk_fma_f32 v[114:115], v[114:115], v[58:59], v[50:51]
    v_pk_fma_f32 v[116:117], v[116:117], v[60:61], v[52:53]
    v_pk_fma_f32 v[118:119], v[118:119], v[62:63], v[54:55]
    v_pk_fma_f32 v[48:49], v[48:49], v[64:65], v[112:113]
    v_pk_fma_f32 v[50:51], v[50:51], v[66:67], v[114:115]
    v_pk_fma_f32 v[52:53], v[52:53], v[68:69], v[116:117]
    v_pk_fma_f32 v[54:55], v[54:55], v[70:71], v[118:119]
    v_pk_fma_f32 v[56:57], v[56:57], v[64:65], v[56:57]
    v_pk_fma_f32 v[58:59], v[58:59], v[66:67], v[58:59]
    v_pk_fma_f32 v[60:61], v[60:61], v[68:69], v[60:61]
    v_pk_fma_f32 v[62:63], v[62:63], v[70:71], v[62:63]
    s_cmp_le_u32 s60, 28
    s_cbranch_scc1 K2_OOL28
K2_S28:
    v_mfma_f32_32x32x8_bf16 v[104:119], v[8:9], v[14:15], v[32:47]
    v_exp_f32 v64, v88
    v_exp_f32 v65, v89
    v_exp_f32 v66, v90
    v_exp_f32 v67, v91
    v_exp_f32 v68, v92
    v_exp_f32 v69, v93
    v_exp_f32 v70, v94
    v_exp_f32 v71, v95
    v_pk_fma_f32 v[88:89], v[88:89], v[56:57], v[48:49]
    v_pk_fma_f32 v[90:91], v[90:91], v[58:59], v[50:51]
    v_pk_fma_f32 v[92:93], v[92:93], v[60:61], v[52:53]
    v_pk_fma_f32 v[94:95], v[94:95], v[62:63], v[54:55]
    v_pk_fma_f32 v[48:49], v[48:49], v[64:65], v[88:89]
    v_pk_fma_f32 v[50:51], v[50:51], v[66:67], v[90:91]
    v_pk_fma_f32 v[52:53], v[52:53], v[68:69], v[92:93]
    v_pk_fma_f32 v[54:55], v[54:55], v[70:71], v[94:95]
    v_pk_fma_f32 v[56:57], v[56:57], v[64:65], v[56:57]
    v_pk_fma_f32 v[58:59], v[58:59], v[66:67], v[58:59]
    v_pk_fma_f32 v[60:61], v[60:61], v[68:69], v[60:61]
    v_pk_fma_f32 v[62:63], v[62:63], v[70:71], v[62:63]
    s_cmp_le_u32 s60, 29
    s_cbranch_scc1 K2_OOL29
K2_S29:
    s_waitcnt vmcnt(2)
    v_mfma_f32_4x4x4_16b_bf16 v[104:107], v[6:7], v[80:81], v[104:107]
    v_exp_f32 v64, v96
    v_mfma_f32_4x4x4_16b_bf16 v[108:111], v[6:7], v[82:83], v[108:111]
    v_exp_f32 v65, v97
    v_mfma_f32_4x4x4_16b_bf16 v[112:115], v[6:7], v[84:85], v[112:115]
    v_exp_f32 v66, v98
    v_mfma_f32_4x4x4_16b_bf16 v[116:119], v[6:7], v[86:87], v[116:119]
    v_exp_f32 v67, v99
    s_waitcnt lgkmcnt(0)
    s_cmp_gt_u32 s59, 34
    s_cselect_b32 s30, 10000, 0
    buffer_load_dwordx4 v[80:83], v[20:21], s[28:31], 0 idxen offen
    buffer_load_dwordx4 v[84:87], v[22:23], s[28:31], 0 idxen offen
    v_exp_f32 v68, v100
    v_exp_f32 v69, v101
    v_exp_f32 v70, v102
    v_exp_f32 v71, v103
    v_lshlrev_b64 v[14:15], v24, v[12:13]
    ds_read_u16 v16, v25 offset:1152
    ds_read_u16 v18, v25 offset:1184
    ds_read_u16 v12, v26 offset:1088
    v_pk_fma_f32 v[96:97], v[96:97], v[56:57], v[48:49]
    v_pk_fma_f32 v[98:99], v[98:99], v[58:59], v[50:51]
    v_pk_fma_f32 v[100:101], v[100:101], v[60:61], v[52:53]
    v_pk_fma_f32 v[102:103], v[102:103], v[62:63], v[54:55]
    v_pk_fma_f32 v[48:49], v[48:49], v[64:65], v[96:97]
    v_pk_fma_f32 v[50:51], v[50:51], v[66:67], v[98:99]
    v_pk_fma_f32 v[52:53], v[52:53], v[68:69], v[100:101]
    v_pk_fma_f32 v[54:55], v[54:55], v[70:71], v[102:103]
    v_pk_fma_f32 v[56:57], v[56:57], v[64:65], v[56:57]
    v_pk_fma_f32 v[58:59], v[58:59], v[66:67], v[58:59]
    v_pk_fma_f32 v[60:61], v[60:61], v[68:69], v[60:61]
    v_pk_fma_f32 v[62:63], v[62:63], v[70:71], v[62:63]
    s_cmp_le_u32 s60, 30
    s_cbranch_scc1 K2_OOL30
K2_S30:
    v_mfma_f32_32x32x8_bf16 v[88:103], v[8:9], v[14:15], v[32:47]
    v_exp_f32 v64, v104
    v_exp_f32 v65, v105
    v_exp_f32 v66, v106
    v_exp_f32 v67, v107
    v_exp_f32 v68, v108
    v_exp_f32 v69, v109
    v_exp_f32 v70, v110
    v_exp_f32 v71, v111
    v_pk_fma_f32 v[104:105], v[104:105], v[56:57], v[48:49]
    v_pk_fma_f32 v[106:107], v[106:107], v[58:59], v[50:51]
    v_pk_fma_f32 v[108:109], v[108:109], v[60:61], v[52:53]
    v_pk_fma_f32 v[110:111], v[110:111], v[62:63], v[54:55]
    v_pk_fma_f32 v[48:49], v[48:49], v[64:65], v[104:105]
    v_pk_fma_f32 v[50:51], v[50:51], v[66:67], v[106:107]
    v_pk_fma_f32 v[52:53], v[52:53], v[68:69], v[108:109]
    v_pk_fma_f32 v[54:55], v[54:55], v[70:71], v[110:111]
    v_pk_fma_f32 v[56:57], v[56:57], v[64:65], v[56:57]
    v_pk_fma_f32 v[58:59], v[58:59], v[66:67], v[58:59]
    v_pk_fma_f32 v[60:61], v[60:61], v[68:69], v[60:61]
    v_pk_fma_f32 v[62:63], v[62:63], v[70:71], v[62:63]
    s_cmp_le_u32 s60, 31
    s_cbranch_scc1 K2_OOL31
K2_S31:
    s_waitcnt vmcnt(2)
    v_mfma_f32_4x4x4_16b_bf16 v[88:91], v[6:7], v[72:73], v[88:91]
    v_exp_f32 v64, v112
    v_mfma_f32_4x4x4_16b_bf16 v[92:95], v[6:7], v[74:75], v[92:95]
    v_exp_f32 v65, v113
    v_mfma_f32_4x4x4_16b_bf16 v[96:99], v[6:7], v[76:77], v[96:99]
    v_exp_f32 v66, v114
    v_mfma_f32_4x4x4_16b_bf16 v[100:103], v[6:7], v[78:79], v[100:103]
    v_exp_f32 v67, v115
    s_waitcnt lgkmcnt(0)
    s_cmp_gt_u32 s59, 36
    s_cselect_b32 s30, 10000, 0
    buffer_load_dwordx4 v[72:75], v[16:17], s[28:31], 0 idxen offen
    buffer_load_dwordx4 v[76:79], v[18:19], s[28:31], 0 idxen offen
    v_exp_f32 v68, v116
    v_exp_f32 v69, v117
    v_exp_f32 v70, v118
    v_exp_f32 v71, v119
    v_lshlrev_b64 v[14:15], v24, v[12:13]
    ds_read_u16 v20, v25 offset:1216
    ds_read_u16 v22, v25 offset:1248
    ds_read_u16 v12, v26 offset:1152
    v_pk_fma_f32 v[112:113], v[112:113], v[56:57], v[48:49]
    v_pk_fma_f32 v[114:115], v[114:115], v[58:59], v[50:51]
    v_pk_fma_f32 v[116:117], v[116:117], v[60:61], v[52:53]
    v_pk_fma_f32 v[118:119], v[118:119], v[62:63], v[54:55]
    v_pk_fma_f32 v[48:49], v[48:49], v[64:65], v[112:113]
    v_pk_fma_f32 v[50:51], v[50:51], v[66:67], v[114:115]
    v_pk_fma_f32 v[52:53], v[52:53], v[68:69], v[116:117]
    v_pk_fma_f32 v[54:55], v[54:55], v[70:71], v[118:119]
    v_pk_fma_f32 v[56:57], v[56:57], v[64:65], v[56:57]
    v_pk_fma_f32 v[58:59], v[58:59], v[66:67], v[58:59]
    v_pk_fma_f32 v[60:61], v[60:61], v[68:69], v[60:61]
    v_pk_fma_f32 v[62:63], v[62:63], v[70:71], v[62:63]
    s_cmp_le_u32 s60, 32
    s_cbranch_scc1 K2_OOL32
K2_S32:
    v_mfma_f32_32x32x8_bf16 v[104:119], v[8:9], v[14:15], v[32:47]
    v_exp_f32 v64, v88
    v_exp_f32 v65, v89
    v_exp_f32 v66, v90
    v_exp_f32 v67, v91
    v_exp_f32 v68, v92
    v_exp_f32 v69, v93
    v_exp_f32 v70, v94
    v_exp_f32 v71, v95
    v_pk_fma_f32 v[88:89], v[88:89], v[56:57], v[48:49]
    v_pk_fma_f32 v[90:91], v[90:91], v[58:59], v[50:51]
    v_pk_fma_f32 v[92:93], v[92:93], v[60:61], v[52:53]
    v_pk_fma_f32 v[94:95], v[94:95], v[62:63], v[54:55]
    v_pk_fma_f32 v[48:49], v[48:49], v[64:65], v[88:89]
    v_pk_fma_f32 v[50:51], v[50:51], v[66:67], v[90:91]
    v_pk_fma_f32 v[52:53], v[52:53], v[68:69], v[92:93]
    v_pk_fma_f32 v[54:55], v[54:55], v[70:71], v[94:95]
    v_pk_fma_f32 v[56:57], v[56:57], v[64:65], v[56:57]
    v_pk_fma_f32 v[58:59], v[58:59], v[66:67], v[58:59]
    v_pk_fma_f32 v[60:61], v[60:61], v[68:69], v[60:61]
    v_pk_fma_f32 v[62:63], v[62:63], v[70:71], v[62:63]
    s_cmp_le_u32 s60, 33
    s_cbranch_scc1 K2_OOL33
K2_S33:
    s_waitcnt vmcnt(2)
    v_mfma_f32_4x4x4_16b_bf16 v[104:107], v[6:7], v[80:81], v[104:107]
    v_exp_f32 v64, v96
    v_mfma_f32_4x4x4_16b_bf16 v[108:111], v[6:7], v[82:83], v[108:111]
    v_exp_f32 v65, v97
    v_mfma_f32_4x4x4_16b_bf16 v[112:115], v[6:7], v[84:85], v[112:115]
    v_exp_f32 v66, v98
    v_mfma_f32_4x4x4_16b_bf16 v[116:119], v[6:7], v[86:87], v[116:119]
    v_exp_f32 v67, v99
    s_waitcnt lgkmcnt(0)
    s_cmp_gt_u32 s59, 38
    s_cselect_b32 s30, 10000, 0
    buffer_load_dwordx4 v[80:83], v[20:21], s[28:31], 0 idxen offen
    buffer_load_dwordx4 v[84:87], v[22:23], s[28:31], 0 idxen offen
    v_exp_f32 v68, v100
    v_exp_f32 v69, v101
    v_exp_f32 v70, v102
    v_exp_f32 v71, v103
    v_lshlrev_b64 v[14:15], v24, v[12:13]
    ds_read_u16 v16, v25 offset:1280
    ds_read_u16 v18, v25 offset:1312
    ds_read_u16 v12, v26 offset:1216
    v_pk_fma_f32 v[96:97], v[96:97], v[56:57], v[48:49]
    v_pk_fma_f32 v[98:99], v[98:99], v[58:59], v[50:51]
    v_pk_fma_f32 v[100:101], v[100:101], v[60:61], v[52:53]
    v_pk_fma_f32 v[102:103], v[102:103], v[62:63], v[54:55]
    v_pk_fma_f32 v[48:49], v[48:49], v[64:65], v[96:97]
    v_pk_fma_f32 v[50:51], v[50:51], v[66:67], v[98:99]
    v_pk_fma_f32 v[52:53], v[52:53], v[68:69], v[100:101]
    v_pk_fma_f32 v[54:55], v[54:55], v[70:71], v[102:103]
    v_pk_fma_f32 v[56:57], v[56:57], v[64:65], v[56:57]
    v_pk_fma_f32 v[58:59], v[58:59], v[66:67], v[58:59]
    v_pk_fma_f32 v[60:61], v[60:61], v[68:69], v[60:61]
    v_pk_fma_f32 v[62:63], v[62:63], v[70:71], v[62:63]
    s_cmp_le_u32 s60, 34
    s_cbranch_scc1 K2_OOL34
K2_S34:
    v_mfma_f32_32x32x8_bf16 v[88:103], v[8:9], v[14:15], v[32:47]
    v_exp_f32 v64, v104
    v_exp_f32 v65, v105
    v_exp_f32 v66, v106
    v_exp_f32 v67, v107
    v_exp_f32 v68, v108
    v_exp_f32 v69, v109
    v_exp_f32 v70, v110
    v_exp_f32 v71, v111
    v_pk_fma_f32 v[104:105], v[104:105], v[56:57], v[48:49]
    v_pk_fma_f32 v[106:107], v[106:107], v[58:59], v[50:51]
    v_pk_fma_f32 v[108:109], v[108:109], v[60:61], v[52:53]
    v_pk_fma_f32 v[110:111], v[110:111], v[62:63], v[54:55]
    v_pk_fma_f32 v[48:49], v[48:49], v[64:65], v[104:105]
    v_pk_fma_f32 v[50:51], v[50:51], v[66:67], v[106:107]
    v_pk_fma_f32 v[52:53], v[52:53], v[68:69], v[108:109]
    v_pk_fma_f32 v[54:55], v[54:55], v[70:71], v[110:111]
    v_pk_fma_f32 v[56:57], v[56:57], v[64:65], v[56:57]
    v_pk_fma_f32 v[58:59], v[58:59], v[66:67], v[58:59]
    v_pk_fma_f32 v[60:61], v[60:61], v[68:69], v[60:61]
    v_pk_fma_f32 v[62:63], v[62:63], v[70:71], v[62:63]
    s_cmp_le_u32 s60, 35
    s_cbranch_scc1 K2_OOL35
K2_S35:
    s_waitcnt vmcnt(2)
    v_mfma_f32_4x4x4_16b_bf16 v[88:91], v[6:7], v[72:73], v[88:91]
    v_exp_f32 v64, v112
    v_mfma_f32_4x4x4_16b_bf16 v[92:95], v[6:7], v[74:75], v[92:95]
    v_exp_f32 v65, v113
    v_mfma_f32_4x4x4_16b_bf16 v[96:99], v[6:7], v[76:77], v[96:99]
    v_exp_f32 v66, v114
    v_mfma_f32_4x4x4_16b_bf16 v[100:103], v[6:7], v[78:79], v[100:103]
    v_exp_f32 v67, v115
    s_waitcnt lgkmcnt(0)
    s_cmp_gt_u32 s59, 40
    s_cselect_b32 s30, 10000, 0
    buffer_load_dwordx4 v[72:75], v[16:17], s[28:31], 0 idxen offen
    buffer_load_dwordx4 v[76:79], v[18:19], s[28:31], 0 idxen offen
    v_exp_f32 v68, v116
    v_exp_f32 v69, v117
    v_exp_f32 v70, v118
    v_exp_f32 v71, v119
    v_lshlrev_b64 v[14:15], v24, v[12:13]
    ds_read_u16 v20, v25 offset:1344
    ds_read_u16 v22, v25 offset:1376
    ds_read_u16 v12, v26 offset:1280
    v_pk_fma_f32 v[112:113], v[112:113], v[56:57], v[48:49]
    v_pk_fma_f32 v[114:115], v[114:115], v[58:59], v[50:51]
    v_pk_fma_f32 v[116:117], v[116:117], v[60:61], v[52:53]
    v_pk_fma_f32 v[118:119], v[118:119], v[62:63], v[54:55]
    v_pk_fma_f32 v[48:49], v[48:49], v[64:65], v[112:113]
    v_pk_fma_f32 v[50:51], v[50:51], v[66:67], v[114:115]
    v_pk_fma_f32 v[52:53], v[52:53], v[68:69], v[116:117]
    v_pk_fma_f32 v[54:55], v[54:55], v[70:71], v[118:119]
    v_pk_fma_f32 v[56:57], v[56:57], v[64:65], v[56:57]
    v_pk_fma_f32 v[58:59], v[58:59], v[66:67], v[58:59]
    v_pk_fma_f32 v[60:61], v[60:61], v[68:69], v[60:61]
    v_pk_fma_f32 v[62:63], v[62:63], v[70:71], v[62:63]
    s_cmp_le_u32 s60, 36
    s_cbranch_scc1 K2_OOL36
K2_S36:
    v_mfma_f32_32x32x8_bf16 v[104:119], v[8:9], v[14:15], v[32:47]
    v_exp_f32 v64, v88
    v_exp_f32 v65, v89
    v_exp_f32 v66, v90
    v_exp_f32 v67, v91
    v_exp_f32 v68, v92
    v_exp_f32 v69, v93
    v_exp_f32 v70, v94
    v_exp_f32 v71, v95
    v_pk_fma_f32 v[88:89], v[88:89], v[56:57], v[48:49]
    v_pk_fma_f32 v[90:91], v[90:91], v[58:59], v[50:51]
    v_pk_fma_f32 v[92:93], v[92:93], v[60:61], v[52:53]
    v_pk_fma_f32 v[94:95], v[94:95], v[62:63], v[54:55]
    v_pk_fma_f32 v[48:49], v[48:49], v[64:65], v[88:89]
    v_pk_fma_f32 v[50:51], v[50:51], v[66:67], v[90:91]
    v_pk_fma_f32 v[52:53], v[52:53], v[68:69], v[92:93]
    v_pk_fma_f32 v[54:55], v[54:55], v[70:71], v[94:95]
    v_pk_fma_f32 v[56:57], v[56:57], v[64:65], v[56:57]
    v_pk_fma_f32 v[58:59], v[58:59], v[66:67], v[58:59]
    v_pk_fma_f32 v[60:61], v[60:61], v[68:69], v[60:61]
    v_pk_fma_f32 v[62:63], v[62:63], v[70:71], v[62:63]
    s_cmp_le_u32 s60, 37
    s_cbranch_scc1 K2_OOL37
K2_S37:
    s_waitcnt vmcnt(2)
    v_mfma_f32_4x4x4_16b_bf16 v[104:107], v[6:7], v[80:81], v[104:107]
    v_exp_f32 v64, v96
    v_mfma_f32_4x4x4_16b_bf16 v[108:111], v[6:7], v[82:83], v[108:111]
    v_exp_f32 v65, v97
    v_mfma_f32_4x4x4_16b_bf16 v[112:115], v[6:7], v[84:85], v[112:115]
    v_exp_f32 v66, v98
    v_mfma_f32_4x4x4_16b_bf16 v[116:119], v[6:7], v[86:87], v[116:119]
    v_exp_f32 v67, v99
    s_waitcnt lgkmcnt(0)
    s_cmp_gt_u32 s59, 42
    s_cselect_b32 s30, 10000, 0
    buffer_load_dwordx4 v[80:83], v[20:21], s[28:31], 0 idxen offen
    buffer_load_dwordx4 v[84:87], v[22:23], s[28:31], 0 idxen offen
    v_exp_f32 v68, v100
    v_exp_f32 v69, v101
    v_exp_f32 v70, v102
    v_exp_f32 v71, v103
    v_lshlrev_b64 v[14:15], v24, v[12:13]
    ds_read_u16 v16, v25 offset:1408
    ds_read_u16 v18, v25 offset:1440
    ds_read_u16 v12, v26 offset:1344
    v_pk_fma_f32 v[96:97], v[96:97], v[56:57], v[48:49]
    v_pk_fma_f32 v[98:99], v[98:99], v[58:59], v[50:51]
    v_pk_fma_f32 v[100:101], v[100:101], v[60:61], v[52:53]
    v_pk_fma_f32 v[102:103], v[102:103], v[62:63], v[54:55]
    v_pk_fma_f32 v[48:49], v[48:49], v[64:65], v[96:97]
    v_pk_fma_f32 v[50:51], v[50:51], v[66:67], v[98:99]
    v_pk_fma_f32 v[52:53], v[52:53], v[68:69], v[100:101]
    v_pk_fma_f32 v[54:55], v[54:55], v[70:71], v[102:103]
    v_pk_fma_f32 v[56:57], v[56:57], v[64:65], v[56:57]
    v_pk_fma_f32 v[58:59], v[58:59], v[66:67], v[58:59]
    v_pk_fma_f32 v[60:61], v[60:61], v[68:69], v[60:61]
    v_pk_fma_f32 v[62:63], v[62:63], v[70:71], v[62:63]
    s_cmp_le_u32 s60, 38
    s_cbranch_scc1 K2_OOL38
K2_S38:
    v_mfma_f32_32x32x8_bf16 v[88:103], v[8:9], v[14:15], v[32:47]
    v_exp_f32 v64, v104
    v_exp_f32 v65, v105
    v_exp_f32 v66, v106
    v_exp_f32 v67, v107
    v_exp_f32 v68, v108
    v_exp_f32 v69, v109
    v_exp_f32 v70, v110
    v_exp_f32 v71, v111
    v_pk_fma_f32 v[104:105], v[104:105], v[56:57], v[48:49]
    v_pk_fma_f32 v[106:107], v[106:107], v[58:59], v[50:51]
    v_pk_fma_f32 v[108:109], v[108:109], v[60:61], v[52:53]
    v_pk_fma_f32 v[110:111], v[110:111], v[62:63], v[54:55]
    v_pk_fma_f32 v[48:49], v[48:49], v[64:65], v[104:105]
    v_pk_fma_f32 v[50:51], v[50:51], v[66:67], v[106:107]
    v_pk_fma_f32 v[52:53], v[52:53], v[68:69], v[108:109]
    v_pk_fma_f32 v[54:55], v[54:55], v[70:71], v[110:111]
    v_pk_fma_f32 v[56:57], v[56:57], v[64:65], v[56:57]
    v_pk_fma_f32 v[58:59], v[58:59], v[66:67], v[58:59]
    v_pk_fma_f32 v[60:61], v[60:61], v[68:69], v[60:61]
    v_pk_fma_f32 v[62:63], v[62:63], v[70:71], v[62:63]
    s_cmp_le_u32 s60, 39
    s_cbranch_scc1 K2_OOL39
K2_S39:
    s_waitcnt vmcnt(2)
    v_mfma_f32_4x4x4_16b_bf16 v[88:91], v[6:7], v[72:73], v[88:91]
    v_exp_f32 v64, v112
    v_mfma_f32_4x4x4_16b_bf16 v[92:95], v[6:7], v[74:75], v[92:95]
    v_exp_f32 v65, v113
    v_mfma_f32_4x4x4_16b_bf16 v[96:99], v[6:7], v[76:77], v[96:99]
    v_exp_f32 v66, v114
    v_mfma_f32_4x4x4_16b_bf16 v[100:103], v[6:7], v[78:79], v[100:103]
    v_exp_f32 v67, v115
    s_waitcnt lgkmcnt(0)
    s_cmp_gt_u32 s59, 44
    s_cselect_b32 s30, 10000, 0
    buffer_load_dwordx4 v[72:75], v[16:17], s[28:31], 0 idxen offen
    buffer_load_dwordx4 v[76:79], v[18:19], s[28:31], 0 idxen offen
    v_exp_f32 v68, v116
    v_exp_f32 v69, v117
    v_exp_f32 v70, v118
    v_exp_f32 v71, v119
    v_lshlrev_b64 v[14:15], v24, v[12:13]
    ds_read_u16 v20, v25 offset:1472
    ds_read_u16 v22, v25 offset:1504
    ds_read_u16 v12, v26 offset:1408
    v_pk_fma_f32 v[112:113], v[112:113], v[56:57], v[48:49]
    v_pk_fma_f32 v[114:115], v[114:115], v[58:59], v[50:51]
    v_pk_fma_f32 v[116:117], v[116:117], v[60:61], v[52:53]
    v_pk_fma_f32 v[118:119], v[118:119], v[62:63], v[54:55]
    v_pk_fma_f32 v[48:49], v[48:49], v[64:65], v[112:113]
    v_pk_fma_f32 v[50:51], v[50:51], v[66:67], v[114:115]
    v_pk_fma_f32 v[52:53], v[52:53], v[68:69], v[116:117]
    v_pk_fma_f32 v[54:55], v[54:55], v[70:71], v[118:119]
    v_pk_fma_f32 v[56:57], v[56:57], v[64:65], v[56:57]
    v_pk_fma_f32 v[58:59], v[58:59], v[66:67], v[58:59]
    v_pk_fma_f32 v[60:61], v[60:61], v[68:69], v[60:61]
    v_pk_fma_f32 v[62:63], v[62:63], v[70:71], v[62:63]
    s_cmp_le_u32 s60, 40
    s_cbranch_scc1 K2_OOL40
K2_S40:
    v_mfma_f32_32x32x8_bf16 v[104:119], v[8:9], v[14:15], v[32:47]
    v_exp_f32 v64, v88
    v_exp_f32 v65, v89
    v_exp_f32 v66, v90
    v_exp_f32 v67, v91
    v_exp_f32 v68, v92
    v_exp_f32 v69, v93
    v_exp_f32 v70, v94
    v_exp_f32 v71, v95
    v_pk_fma_f32 v[88:89], v[88:89], v[56:57], v[48:49]
    v_pk_fma_f32 v[90:91], v[90:91], v[58:59], v[50:51]
    v_pk_fma_f32 v[92:93], v[92:93], v[60:61], v[52:53]
    v_pk_fma_f32 v[94:95], v[94:95], v[62:63], v[54:55]
    v_pk_fma_f32 v[48:49], v[48:49], v[64:65], v[88:89]
    v_pk_fma_f32 v[50:51], v[50:51], v[66:67], v[90:91]
    v_pk_fma_f32 v[52:53], v[52:53], v[68:69], v[92:93]
    v_pk_fma_f32 v[54:55], v[54:55], v[70:71], v[94:95]
    v_pk_fma_f32 v[56:57], v[56:57], v[64:65], v[56:57]
    v_pk_fma_f32 v[58:59], v[58:59], v[66:67], v[58:59]
    v_pk_fma_f32 v[60:61], v[60:61], v[68:69], v[60:61]
    v_pk_fma_f32 v[62:63], v[62:63], v[70:71], v[62:63]
    s_cmp_le_u32 s60, 41
    s_cbranch_scc1 K2_OOL41
K2_S41:
    s_waitcnt vmcnt(2)
    v_mfma_f32_4x4x4_16b_bf16 v[104:107], v[6:7], v[80:81], v[104:107]
    v_exp_f32 v64, v96
    v_mfma_f32_4x4x4_16b_bf16 v[108:111], v[6:7], v[82:83], v[108:111]
    v_exp_f32 v65, v97
    v_mfma_f32_4x4x4_16b_bf16 v[112:115], v[6:7], v[84:85], v[112:115]
    v_exp_f32 v66, v98
    v_mfma_f32_4x4x4_16b_bf16 v[116:119], v[6:7], v[86:87], v[116:119]
    v_exp_f32 v67, v99
    s_waitcnt lgkmcnt(0)
    s_cmp_gt_u32 s59, 46
    s_cselect_b32 s30, 10000, 0
    buffer_load_dwordx4 v[80:83], v[20:21], s[28:31], 0 idxen offen
    buffer_load_dwordx4 v[84:87], v[22:23], s[28:31], 0 idxen offen
    v_exp_f32 v68, v100
    v_exp_f32 v69, v101
    v_exp_f32 v70, v102
    v_exp_f32 v71, v103
    v_lshlrev_b64 v[14:15], v24, v[12:13]
    ds_read_u16 v12, v26 offset:1472
    v_pk_fma_f32 v[96:97], v[96:97], v[56:57], v[48:49]
    v_pk_fma_f32 v[98:99], v[98:99], v[58:59], v[50:51]
    v_pk_fma_f32 v[100:101], v[100:101], v[60:61], v[52:53]
    v_pk_fma_f32 v[102:103], v[102:103], v[62:63], v[54:55]
    v_pk_fma_f32 v[48:49], v[48:49], v[64:65], v[96:97]
    v_pk_fma_f32 v[50:51], v[50:51], v[66:67], v[98:99]
    v_pk_fma_f32 v[52:53], v[52:53], v[68:69], v[100:101]
    v_pk_fma_f32 v[54:55], v[54:55], v[70:71], v[102:103]
    v_pk_fma_f32 v[56:57], v[56:57], v[64:65], v[56:57]
    v_pk_fma_f32 v[58:59], v[58:59], v[66:67], v[58:59]
    v_pk_fma_f32 v[60:61], v[60:61], v[68:69], v[60:61]
    v_pk_fma_f32 v[62:63], v[62:63], v[70:71], v[62:63]
    s_cmp_le_u32 s60, 42
    s_cbranch_scc1 K2_OOL42
K2_S42:
    v_mfma_f32_32x32x8_bf16 v[88:103], v[8:9], v[14:15], v[32:47]
    v_exp_f32 v64, v104
    v_exp_f32 v65, v105
    v_exp_f32 v66, v106
    v_exp_f32 v67, v107
    v_exp_f32 v68, v108
    v_exp_f32 v69, v109
    v_exp_f32 v70, v110
    v_exp_f32 v71, v111
    v_pk_fma_f32 v[104:105], v[104:105], v[56:57], v[48:49]
    v_pk_fma_f32 v[106:107], v[106:107], v[58:59], v[50:51]
    v_pk_fma_f32 v[108:109], v[108:109], v[60:61], v[52:53]
    v_pk_fma_f32 v[110:111], v[110:111], v[62:63], v[54:55]
    v_pk_fma_f32 v[48:49], v[48:49], v[64:65], v[104:105]
    v_pk_fma_f32 v[50:51], v[50:51], v[66:67], v[106:107]
    v_pk_fma_f32 v[52:53], v[52:53], v[68:69], v[108:109]
    v_pk_fma_f32 v[54:55], v[54:55], v[70:71], v[110:111]
    v_pk_fma_f32 v[56:57], v[56:57], v[64:65], v[56:57]
    v_pk_fma_f32 v[58:59], v[58:59], v[66:67], v[58:59]
    v_pk_fma_f32 v[60:61], v[60:61], v[68:69], v[60:61]
    v_pk_fma_f32 v[62:63], v[62:63], v[70:71], v[62:63]
    s_cmp_le_u32 s60, 43
    s_cbranch_scc1 K2_OOL43
K2_S43:
    s_waitcnt vmcnt(2)
    v_mfma_f32_4x4x4_16b_bf16 v[88:91], v[6:7], v[72:73], v[88:91]
    v_exp_f32 v64, v112
    v_mfma_f32_4x4x4_16b_bf16 v[92:95], v[6:7], v[74:75], v[92:95]
    v_exp_f32 v65, v113
    v_mfma_f32_4x4x4_16b_bf16 v[96:99], v[6:7], v[76:77], v[96:99]
    v_exp_f32 v66, v114
    v_mfma_f32_4x4x4_16b_bf16 v[100:103], v[6:7], v[78:79], v[100:103]
    v_exp_f32 v67, v115
    s_waitcnt lgkmcnt(0)
    v_exp_f32 v68, v116
    v_exp_f32 v69, v117
    v_exp_f32 v70, v118
    v_exp_f32 v71, v119
    v_lshlrev_b64 v[14:15], v24, v[12:13]
    v_pk_fma_f32 v[112:113], v[112:113], v[56:57], v[48:49]
    v_pk_fma_f32 v[114:115], v[114:115], v[58:59], v[50:51]
    v_pk_fma_f32 v[116:117], v[116:117], v[60:61], v[52:53]
    v_pk_fma_f32 v[118:119], v[118:119], v[62:63], v[54:55]
    v_pk_fma_f32 v[48:49], v[48:49], v[64:65], v[112:113]
    v_pk_fma_f32 v[50:51], v[50:51], v[66:67], v[114:115]
    v_pk_fma_f32 v[52:53], v[52:53], v[68:69], v[116:117]
    v_pk_fma_f32 v[54:55], v[54:55], v[70:71], v[118:119]
    v_pk_fma_f32 v[56:57], v[56:57], v[64:65], v[56:57]
    v_pk_fma_f32 v[58:59], v[58:59], v[66:67], v[58:59]
    v_pk_fma_f32 v[60:61], v[60:61], v[68:69], v[60:61]
    v_pk_fma_f32 v[62:63], v[62:63], v[70:71], v[62:63]
    s_cmp_le_u32 s60, 44
    s_cbranch_scc1 K2_OOL44
K2_S44:
    v_mfma_f32_32x32x8_bf16 v[104:119], v[8:9], v[14:15], v[32:47]
    v_exp_f32 v64, v88
    v_exp_f32 v65, v89
    v_exp_f32 v66, v90
    v_exp_f32 v67, v91
    v_exp_f32 v68, v92
    v_exp_f32 v69, v93
    v_exp_f32 v70, v94
    v_exp_f32 v71, v95
    v_pk_fma_f32 v[88:89], v[88:89], v[56:57], v[48:49]
    v_pk_fma_f32 v[90:91], v[90:91], v[58:59], v[50:51]
    v_pk_fma_f32 v[92:93], v[92:93], v[60:61], v[52:53]
    v_pk_fma_f32 v[94:95], v[94:95], v[62:63], v[54:55]
    v_pk_fma_f32 v[48:49], v[48:49], v[64:65], v[88:89]
    v_pk_fma_f32 v[50:51], v[50:51], v[66:67], v[90:91]
    v_pk_fma_f32 v[52:53], v[52:53], v[68:69], v[92:93]
    v_pk_fma_f32 v[54:55], v[54:55], v[70:71], v[94:95]
    v_pk_fma_f32 v[56:57], v[56:57], v[64:65], v[56:57]
    v_pk_fma_f32 v[58:59], v[58:59], v[66:67], v[58:59]
    v_pk_fma_f32 v[60:61], v[60:61], v[68:69], v[60:61]
    v_pk_fma_f32 v[62:63], v[62:63], v[70:71], v[62:63]
    s_cmp_le_u32 s60, 45
    s_cbranch_scc1 K2_OOL45
K2_S45:
    s_waitcnt vmcnt(0)
    v_mfma_f32_4x4x4_16b_bf16 v[104:107], v[6:7], v[80:81], v[104:107]
    v_exp_f32 v64, v96
    v_mfma_f32_4x4x4_16b_bf16 v[108:111], v[6:7], v[82:83], v[108:111]
    v_exp_f32 v65, v97
    v_mfma_f32_4x4x4_16b_bf16 v[112:115], v[6:7], v[84:85], v[112:115]
    v_exp_f32 v66, v98
    v_mfma_f32_4x4x4_16b_bf16 v[116:119], v[6:7], v[86:87], v[116:119]
    v_exp_f32 v67, v99
    v_exp_f32 v68, v100
    v_exp_f32 v69, v101
    v_exp_f32 v70, v102
    v_exp_f32 v71, v103
    v_pk_fma_f32 v[96:97], v[96:97], v[56:57], v[48:49]
    v_pk_fma_f32 v[98:99], v[98:99], v[58:59], v[50:51]
    v_pk_fma_f32 v[100:101], v[100:101], v[60:61], v[52:53]
    v_pk_fma_f32 v[102:103], v[102:103], v[62:63], v[54:55]
    v_pk_fma_f32 v[48:49], v[48:49], v[64:65], v[96:97]
    v_pk_fma_f32 v[50:51], v[50:51], v[66:67], v[98:99]
    v_pk_fma_f32 v[52:53], v[52:53], v[68:69], v[100:101]
    v_pk_fma_f32 v[54:55], v[54:55], v[70:71], v[102:103]
    v_pk_fma_f32 v[56:57], v[56:57], v[64:65], v[56:57]
    v_pk_fma_f32 v[58:59], v[58:59], v[66:67], v[58:59]
    v_pk_fma_f32 v[60:61], v[60:61], v[68:69], v[60:61]
    v_pk_fma_f32 v[62:63], v[62:63], v[70:71], v[62:63]
    s_cmp_le_u32 s60, 46
    s_cbranch_scc1 K2_OOL46
K2_S46:
    v_exp_f32 v64, v104
    v_exp_f32 v65, v105
    v_exp_f32 v66, v106
    v_exp_f32 v67, v107
    v_exp_f32 v68, v108
    v_exp_f32 v69, v109
    v_exp_f32 v70, v110
    v_exp_f32 v71, v111
    v_pk_fma_f32 v[104:105], v[104:105], v[56:57], v[48:49]
    v_pk_fma_f32 v[106:107], v[106:107], v[58:59], v[50:51]
    v_pk_fma_f32 v[108:109], v[108:109], v[60:61], v[52:53]
    v_pk_fma_f32 v[110:111], v[110:111], v[62:63], v[54:55]
    v_pk_fma_f32 v[48:49], v[48:49], v[64:65], v[104:105]
    v_pk_fma_f32 v[50:51], v[50:51], v[66:67], v[106:107]
    v_pk_fma_f32 v[52:53], v[52:53], v[68:69], v[108:109]
    v_pk_fma_f32 v[54:55], v[54:55], v[70:71], v[110:111]
    v_pk_fma_f32 v[56:57], v[56:57], v[64:65], v[56:57]
    v_pk_fma_f32 v[58:59], v[58:59], v[66:67], v[58:59]
    v_pk_fma_f32 v[60:61], v[60:61], v[68:69], v[60:61]
    v_pk_fma_f32 v[62:63], v[62:63], v[70:71], v[62:63]
    s_cmp_le_u32 s60, 47
    s_cbranch_scc1 K2_OOL47
K2_S47:
    v_exp_f32 v64, v112
    v_exp_f32 v65, v113
    v_exp_f32 v66, v114
    v_exp_f32 v67, v115
    v_exp_f32 v68, v116
    v_exp_f32 v69, v117
    v_exp_f32 v70, v118
    v_exp_f32 v71, v119
    v_pk_fma_f32 v[112:113], v[112:113], v[56:57], v[48:49]
    v_pk_fma_f32 v[114:115], v[114:115], v[58:59], v[50:51]
    v_pk_fma_f32 v[116:117], v[116:117], v[60:61], v[52:53]
    v_pk_fma_f32 v[118:119], v[118:119], v[62:63], v[54:55]
    v_pk_fma_f32 v[48:49], v[48:49], v[64:65], v[112:113]
    v_pk_fma_f32 v[50:51], v[50:51], v[66:67], v[114:115]
    v_pk_fma_f32 v[52:53], v[52:53], v[68:69], v[116:117]
    v_pk_fma_f32 v[54:55], v[54:55], v[70:71], v[118:119]
    v_pk_fma_f32 v[56:57], v[56:57], v[64:65], v[56:57]
    v_pk_fma_f32 v[58:59], v[58:59], v[66:67], v[58:59]
    v_pk_fma_f32 v[60:61], v[60:61], v[68:69], v[60:61]
    v_pk_fma_f32 v[62:63], v[62:63], v[70:71], v[62:63]
K2_FIN:
    s_mov_b64 exec, 1
    ds_add_rtn_u32 v120, v126, v123
    s_mov_b64 exec, -1
    s_setprio 3
    s_lshr_b32 s84, s58, 10
    s_add_u32 s84, s84, 1
    s_cmp_lt_u32 s84, 3
    s_cselect_b32 s84, s84, 0
    v_pk_mul_f32 v[2:3], v[56:57], v[58:59]
    v_pk_mul_f32 v[4:5], v[48:49], v[50:51]
    v_pk_fma_f32 v[2:3], v[60:61], v[62:63], v[2:3]
    v_pk_fma_f32 v[4:5], v[52:53], v[54:55], v[4:5]
    v_pk_fma_f32 v[2:3], v[4:5], 0, v[2:3] op_sel_hi:[1,0,1]
    v_add_f32 v2, v2, v3
    v_cmp_ngt_f32 vcc, s64, v2
    s_waitcnt lgkmcnt(0)
    v_readfirstlane_b32 s58, v120
    s_cbranch_vccnz K2_SAFE
K2_NEXT:
    s_cmp_lt_u32 s52, 4
    s_cbranch_scc1 K2_IWB
K2_IWBD:
    s_add_u32 s58, s58, 1024
    s_cmp_lt_u32 s58, 2560
    s_cbranch_scc1 K2_GROUP
    s_and_b32 s68, s52, 7
    s_lshr_b32 s69, s52, 3
    s_and_b32 s56, s53, 1
    s_lshr_b32 s70, s68, 2
    s_xor_b32 s70, s70, s56
    s_mov_b64 exec, 1
    ds_add_rtn_u32 v2, v126, v123 offset:80
    s_mov_b64 exec, -1
    s_waitcnt lgkmcnt(0)
    v_readfirstlane_b32 s71, v2
    s_cmp_lt_u32 s71, 0
    s_cbranch_scc1 K2_TE
    s_cmp_lg_u32 s84, 0
    s_cbranch_scc1 K2_TL
    s_cmp_eq_u32 s69, 0
    s_cbranch_scc1 K2_BLA
    s_lshl_b32 s56, s68, 15
    s_lshl_b32 s57, s69, 14
    s_add_u32 s56, s56, s57
    buffer_load_dwordx4 v[32:35], v124, s[44:47], s56 offen offset:0
    buffer_load_dwordx4 v[36:39], v124, s[44:47], s56 offen offset:1024
    buffer_load_dwordx4 v[40:43], v124, s[44:47], s56 offen offset:2048
    buffer_load_dwordx4 v[44:47], v124, s[44:47], s56 offen offset:3072
    s_add_u32 s56, s56, 4096
    buffer_load_dwordx4 v[88:91], v124, s[44:47], s56 offen offset:0
    buffer_load_dwordx4 v[92:95], v124, s[44:47], s56 offen offset:1024
    buffer_load_dwordx4 v[96:99], v124, s[44:47], s56 offen offset:2048
    buffer_load_dwordx4 v[100:103], v124, s[44:47], s56 offen offset:3072
    s_add_u32 s56, s56, 4096
    buffer_load_dwordx4 v[104:107], v124, s[44:47], s56 offen offset:0
    buffer_load_dwordx4 v[108:111], v124, s[44:47], s56 offen offset:1024
    buffer_load_dwordx4 v[112:115], v124, s[44:47], s56 offen offset:2048
    buffer_load_dwordx4 v[116:119], v124, s[44:47], s56 offen offset:3072
    s_add_u32 s56, s56, 4096
    buffer_load_dwordx4 v[72:75], v124, s[44:47], s56 offen offset:0
    buffer_load_dwordx4 v[76:79], v124, s[44:47], s56 offen offset:1024
    buffer_load_dwordx4 v[80:83], v124, s[44:47], s56 offen offset:2048
    buffer_load_dwordx4 v[84:87], v124, s[44:47], s56 offen offset:3072
    s_branch K2_BXA
K2_BLA:
    s_lshl_b32 s56, s68, 15
    s_lshl_b32 s57, s69, 14
    s_add_u32 s56, s56, s57
    s_add_u32 s56, s56, 12288
    buffer_load_dwordx4 v[72:75], v124, s[44:47], s56 offen offset:0
    buffer_load_dwordx4 v[76:79], v124, s[44:47], s56 offen offset:1024
    buffer_load_dwordx4 v[80:83], v124, s[44:47], s56 offen offset:2048
    buffer_load_dwordx4 v[84:87], v124, s[44:47], s56 offen offset:3072
K2_BXA:
    v_rcp_f32 v64, v56
    v_rcp_f32 v65, v57
    v_rcp_f32 v66, v58
    v_rcp_f32 v67, v59
    v_rcp_f32 v68, v60
    v_rcp_f32 v69, v61
    v_rcp_f32 v70, v62
    v_rcp_f32 v71, v63
    v_pk_mul_f32 v[48:49], v[48:49], v[64:65]
    v_pk_mul_f32 v[50:51], v[50:51], v[66:67]
    v_pk_mul_f32 v[52:53], v[52:53], v[68:69]
    v_pk_mul_f32 v[54:55], v[54:55], v[70:71]
    v_cvt_pk_bf16_f32 v64, v48, v49
    v_cvt_pk_bf16_f32 v65, v50, v51
    v_cvt_pk_bf16_f32 v66, v52, v53
    v_cvt_pk_bf16_f32 v67, v54, v55
    buffer_store_dwordx4 v[64:67], v28, s[36:39], s61 offen sc1
    s_branch K2_TC
K2_TL:
    v_rcp_f32 v64, v56
    v_rcp_f32 v65, v57
    v_rcp_f32 v66, v58
    v_rcp_f32 v67, v59
    v_rcp_f32 v68, v60
    v_rcp_f32 v69, v61
    v_rcp_f32 v70, v62
    v_rcp_f32 v71, v63
    v_pk_mul_f32 v[48:49], v[48:49], v[64:65]
    v_pk_mul_f32 v[50:51], v[50:51], v[66:67]
    v_pk_mul_f32 v[52:53], v[52:53], v[68:69]
    v_pk_mul_f32 v[54:55], v[54:55], v[70:71]
    v_cvt_pk_bf16_f32 v64, v48, v49
    v_cvt_pk_bf16_f32 v65, v50, v51
    v_cvt_pk_bf16_f32 v66, v52, v53
    v_cvt_pk_bf16_f32 v67, v54, v55
    buffer_store_dwordx4 v[64:67], v28, s[36:39], s61 offen sc1
    s_cmp_eq_u32 s69, 0
    s_cbranch_scc1 K2_BLC
    s_lshl_b32 s56, s68, 15
    s_lshl_b32 s57, s69, 14
    s_add_u32 s56, s56, s57
    buffer_load_dwordx4 v[32:35], v124, s[44:47], s56 offen offset:0
    buffer_load_dwordx4 v[36:39], v124, s[44:47], s56 offen offset:1024
    buffer_load_dwordx4 v[40:43], v124, s[44:47], s56 offen offset:2048
    buffer_load_dwordx4 v[44:47], v124, s[44:47], s56 offen offset:3072
    s_add_u32 s56, s56, 4096
    buffer_load_dwordx4 v[88:91], v124, s[44:47], s56 offen offset:0
    buffer_load_dwordx4 v[92:95], v124, s[44:47], s56 offen offset:1024
    buffer_load_dwordx4 v[96:99], v124, s[44:47], s56 offen offset:2048
    buffer_load_dwordx4 v[100:103], v124, s[44:47], s56 offen offset:3072
    s_add_u32 s56, s56, 4096
    buffer_load_dwordx4 v[104:107], v124, s[44:47], s56 offen offset:0
    buffer_load_dwordx4 v[108:111], v124, s[44:47], s56 offen offset:1024
    buffer_load_dwordx4 v[112:115], v124, s[44:47], s56 offen offset:2048
    buffer_load_dwordx4 v[116:119], v124, s[44:47], s56 offen offset:3072
    s_add_u32 s56, s56, 4096
    buffer_load_dwordx4 v[72:75], v124, s[44:47], s56 offen offset:0
    buffer_load_dwordx4 v[76:79], v124, s[44:47], s56 offen offset:1024
    buffer_load_dwordx4 v[80:83], v124, s[44:47], s56 offen offset:2048
    buffer_load_dwordx4 v[84:87], v124, s[44:47], s56 offen offset:3072
    s_branch K2_BXC
K2_BLC:
    s_lshl_b32 s56, s68, 15
    s_lshl_b32 s57, s69, 14
    s_add_u32 s56, s56, s57
    s_add_u32 s56, s56, 12288
    buffer_load_dwordx4 v[72:75], v124, s[44:47], s56 offen offset:0
    buffer_load_dwordx4 v[76:79], v124, s[44:47], s56 offen offset:1024
    buffer_load_dwordx4 v[80:83], v124, s[44:47], s56 offen offset:2048
    buffer_load_dwordx4 v[84:87], v124, s[44:47], s56 offen offset:3072
K2_BXC:
    s_cmp_eq_u32 s69, 0
    s_cbranch_scc1 K2_TL0
    s_waitcnt vmcnt(16)
    s_branch K2_TL1
K2_TL0:
    s_waitcnt vmcnt(4)
K2_TL1:
    s_mov_b64 s[86:87], exec
    s_mov_b64 exec, 1
    s_lshl_b32 s56, s84, 2
    v_add_u32 v2, s56, v126
    ds_add_rtn_u32 v2, v2, v123 offset:64
    s_lshl_b32 s56, s84, 3
    s_add_u32 s56, s56, s53
    s_sub_u32 s56, s56, 8
    s_lshl_b32 s56, s56, 7
    v_mov_b32 v3, s56
    s_mov_b32 s84, 0
    s_waitcnt lgkmcnt(0)
    v_readfirstlane_b32 s56, v2
    s_cmp_lg_u32 s56, 960
    s_cbranch_scc1 K2_CEL
    buffer_store_dword v123, v3, s[80:83], 0 offen sc1
K2_CEL:
    s_mov_b64 exec, s[86:87]
    s_branch K2_TC
K2_TE:
    v_rcp_f32 v64, v56
    v_rcp_f32 v65, v57
    v_rcp_f32 v66, v58
    v_rcp_f32 v67, v59
    v_rcp_f32 v68, v60
    v_rcp_f32 v69, v61
    v_rcp_f32 v70, v62
    v_rcp_f32 v71, v63
    v_pk_mul_f32 v[48:49], v[48:49], v[64:65]
    v_pk_mul_f32 v[50:51], v[50:51], v[66:67]
    v_pk_mul_f32 v[52:53], v[52:53], v[68:69]
    v_pk_mul_f32 v[54:55], v[54:55], v[70:71]
    v_cvt_pk_bf16_f32 v64, v48, v49
    v_cvt_pk_bf16_f32 v65, v50, v51
    v_cvt_pk_bf16_f32 v66, v52, v53
    v_cvt_pk_bf16_f32 v67, v54, v55
    buffer_store_dwordx4 v[64:67], v28, s[36:39], s61 offen sc1
K2_TAIL:
    s_nop 0
    s_cmp_eq_u32 s84, 0
    s_cbranch_scc1 K2_TAIL2
    s_waitcnt vmcnt(0)
    s_mov_b64 s[86:87], exec
    s_mov_b64 exec, 1
    s_lshl_b32 s56, s84, 2
    v_add_u32 v2, s56, v126
    ds_add_rtn_u32 v2, v2, v123 offset:64
    s_lshl_b32 s56, s84, 3
    s_add_u32 s56, s56, s53
    s_sub_u32 s56, s56, 8
    s_lshl_b32 s56, s56, 7
    v_mov_b32 v3, s56
    s_mov_b32 s84, 0
    s_waitcnt lgkmcnt(0)
    v_readfirstlane_b32 s56, v2
    s_cmp_lg_u32 s56, 960
    s_cbranch_scc1 K2_CEC
    buffer_store_dword v123, v3, s[80:83], 0 offen sc1
K2_CEC:
    s_mov_b64 exec, s[86:87]
K2_TAIL2:
    s_cmp_eq_u32 s69, 0
    s_cbranch_scc1 K2_BLB
    s_lshl_b32 s56, s68, 15
    s_lshl_b32 s57, s69, 14
    s_add_u32 s56, s56, s57
    buffer_load_dwordx4 v[32:35], v124, s[44:47], s56 offen offset:0
    buffer_load_dwordx4 v[36:39], v124, s[44:47], s56 offen offset:1024
    buffer_load_dwordx4 v[40:43], v124, s[44:47], s56 offen offset:2048
    buffer_load_dwordx4 v[44:47], v124, s[44:47], s56 offen offset:3072
    s_add_u32 s56, s56, 4096
    s_waitcnt vmcnt(0)
    buffer_load_dwordx4 v[88:91], v124, s[44:47], s56 offen offset:0
    buffer_load_dwordx4 v[92:95], v124, s[44:47], s56 offen offset:1024
    buffer_load_dwordx4 v[96:99], v124, s[44:47], s56 offen offset:2048
    buffer_load_dwordx4 v[100:103], v124, s[44:47], s56 offen offset:3072
    s_add_u32 s56, s56, 4096
    s_waitcnt vmcnt(0)
    buffer_load_dwordx4 v[104:107], v124, s[44:47], s56 offen offset:0
    buffer_load_dwordx4 v[108:111], v124, s[44:47], s56 offen offset:1024
    buffer_load_dwordx4 v[112:115], v124, s[44:47], s56 offen offset:2048
    buffer_load_dwordx4 v[116:119], v124, s[44:47], s56 offen offset:3072
    s_add_u32 s56, s56, 4096
    s_waitcnt vmcnt(0)
    buffer_load_dwordx4 v[72:75], v124, s[44:47], s56 offen offset:0
    buffer_load_dwordx4 v[76:79], v124, s[44:47], s56 offen offset:1024
    buffer_load_dwordx4 v[80:83], v124, s[44:47], s56 offen offset:2048
    buffer_load_dwordx4 v[84:87], v124, s[44:47], s56 offen offset:3072
    s_branch K2_BXB
K2_BLB:
    s_lshl_b32 s56, s68, 15
    s_lshl_b32 s57, s69, 14
    s_add_u32 s56, s56, s57
    s_add_u32 s56, s56, 12288
    buffer_load_dwordx4 v[72:75], v124, s[44:47], s56 offen offset:0
    buffer_load_dwordx4 v[76:79], v124, s[44:47], s56 offen offset:1024
    buffer_load_dwordx4 v[80:83], v124, s[44:47], s56 offen offset:2048
    buffer_load_dwordx4 v[84:87], v124, s[44:47], s56 offen offset:3072
K2_BXB:
K2_TC:
    s_nop 0
    s_mov_b32 s48, s18
    s_and_b32 s49, s19, 0xffff
    s_mov_b32 s50, 512
    s_mov_b32 s51, 0x20000
    s_cmp_ge_u32 s71, 256
    s_cbranch_scc1 K2_NF0
    s_cmp_lg_u32 s71, 0
    s_cbranch_scc1 K2_SPF0
    s_mov_b64 exec, 0xff
    v_lshlrev_b32 v4, 7, v1
    s_mov_b32 s57, 0
K2_P0:
    buffer_load_dword v3, v4, s[80:83], 0 offen offset:0 sc1
    s_add_u32 s57, s57, 1
    s_waitcnt vmcnt(0)
    v_cmp_eq_u32 vcc, 0, v3
    s_cbranch_vccz K2_P0D
    s_cmp_lt_u32 s57, 0x400000
    s_cbranch_scc1 K2_P0
K2_P0D:
    s_mov_b64 exec, -1
    ds_write_b32 v126, v123 offset:88
K2_SPF0:
    ds_read_b32 v2, v126 offset:88
    s_waitcnt lgkmcnt(0)
    v_readfirstlane_b32 s56, v2
    s_cmp_lt_u32 s56, 1
    s_cbranch_scc1 K2_SPF0
    s_lshr_b32 s56, s53, 0
    s_add_u32 s56, s56, 0
    s_lshl_b32 s56, s56, 14
    s_lshl_b32 s57, s71, 6
    s_add_u32 s56, s56, s57
    buffer_load_dwordx4 v[8:11], v124, s[36:39], s56 offen offset:0 sc1
    buffer_load_dwordx4 v[12:15], v124, s[36:39], s56 offen offset:1024 sc1
    buffer_load_dwordx4 v[16:19], v124, s[36:39], s56 offen offset:2048 sc1
    buffer_load_dwordx4 v[20:23], v124, s[36:39], s56 offen offset:3072 sc1
    s_add_u32 s57, s57, 126976
    v_add_u32 v125, s57, v124
    s_waitcnt vmcnt(3)
    ds_write_b128 v125, v[8:11] offset:0
    s_waitcnt vmcnt(2)
    ds_write_b128 v125, v[12:15] offset:1024
    s_waitcnt vmcnt(1)
    ds_write_b128 v125, v[16:19] offset:2048
    s_waitcnt vmcnt(0)
    ds_write_b128 v125, v[20:23] offset:3072
    s_mov_b32 s71, 512
K2_NF0:
    s_cmp_lt_u32 s71, 512
    s_cbranch_scc1 K2_SPW
    s_setprio 0
    s_cmp_eq_u32 s69, 0
    s_cbranch_scc0 K2_T1
K2_SPW:
    ds_read_b32 v2, v126 offset:72
    s_waitcnt lgkmcnt(0)
    v_readfirstlane_b32 s56, v2
    s_cmp_lt_u32 s56, 1024
    s_cbranch_scc1 K2_SPW
    s_cmp_eq_u32 s69, 0
    s_cbranch_scc0 K2_T1
    s_mul_i32 s56, s68, 12288
    s_add_u32 s56, s56, 28672
    v_add_u32 v2, s56, v124
    ds_read_b128 v[32:35], v2 offset:0
    ds_read_b128 v[36:39], v2 offset:1024
    ds_read_b128 v[40:43], v2 offset:2048
    ds_read_b128 v[44:47], v2 offset:3072
    ds_read_b128 v[88:91], v2 offset:4096
    ds_read_b128 v[92:95], v2 offset:5120
    ds_read_b128 v[96:99], v2 offset:6144
    ds_read_b128 v[100:103], v2 offset:7168
    ds_read_b128 v[104:107], v2 offset:8192
    ds_read_b128 v[108:111], v2 offset:9216
    ds_read_b128 v[112:115], v2 offset:10240
    ds_read_b128 v[116:119], v2 offset:11264
K2_T1:
    s_waitcnt vmcnt(0)
    s_mov_b32 s84, 3
    s_mov_b64 s[86:87], exec
    s_mov_b64 exec, 1
    s_lshl_b32 s56, s84, 2
    v_add_u32 v2, s56, v126
    ds_add_rtn_u32 v2, v2, v123 offset:64
    s_lshl_b32 s56, s84, 3
    s_add_u32 s56, s56, s53
    s_sub_u32 s56, s56, 8
    s_lshl_b32 s56, s56, 7
    v_mov_b32 v3, s56
    s_mov_b32 s84, 0
    s_waitcnt lgkmcnt(0)
    v_readfirstlane_b32 s56, v2
    s_cmp_lg_u32 s56, 960
    s_cbranch_scc1 K2_CED
    buffer_store_dword v123, v3, s[80:83], 0 offen sc1
K2_CED:
    s_mov_b64 exec, s[86:87]
    s_cmp_ge_u32 s71, 512
    s_cbranch_scc1 K2_NF1
    s_sub_u32 s71, s71, 256
    s_cmp_lg_u32 s71, 0
    s_cbranch_scc1 K2_SPF1
    s_mov_b64 exec, 0xff
    v_lshlrev_b32 v4, 7, v1
    s_mov_b32 s57, 0
K2_P1:
    buffer_load_dword v3, v4, s[80:83], 0 offen offset:1024 sc1
    s_add_u32 s57, s57, 1
    s_waitcnt vmcnt(0)
    v_cmp_eq_u32 vcc, 0, v3
    s_cbranch_vccz K2_P1D
    s_cmp_lt_u32 s57, 0x400000
    s_cbranch_scc1 K2_P1
K2_P1D:
    s_mov_b64 exec, -1
    ds_write_b32 v126, v123 offset:92
K2_SPF1:
    ds_read_b32 v2, v126 offset:92
    s_waitcnt lgkmcnt(0)
    v_readfirstlane_b32 s56, v2
    s_cmp_lt_u32 s56, 1
    s_cbranch_scc1 K2_SPF1
    s_lshr_b32 s56, s53, 0
    s_add_u32 s56, s56, 8
    s_lshl_b32 s56, s56, 14
    s_lshl_b32 s57, s71, 6
    s_add_u32 s56, s56, s57
    buffer_load_dwordx4 v[8:11], v124, s[36:39], s56 offen offset:0 sc1
    buffer_load_dwordx4 v[12:15], v124, s[36:39], s56 offen offset:1024 sc1
    buffer_load_dwordx4 v[16:19], v124, s[36:39], s56 offen offset:2048 sc1
    buffer_load_dwordx4 v[20:23], v124, s[36:39], s56 offen offset:3072 sc1
    s_add_u32 s57, s57, 143360
    v_add_u32 v125, s57, v124
    s_waitcnt vmcnt(3)
    ds_write_b128 v125, v[8:11] offset:0
    s_waitcnt vmcnt(2)
    ds_write_b128 v125, v[12:15] offset:1024
    s_waitcnt vmcnt(1)
    ds_write_b128 v125, v[16:19] offset:2048
    s_waitcnt vmcnt(0)
    ds_write_b128 v125, v[20:23] offset:3072
K2_NF1:
    v_and_b32 v2, 15, v1
    v_lshlrev_b32 v2, 2, v2
    s_lshl_b32 s56, s68, 6
    v_add_u32 v121, s56, v2
    buffer_load_dword v28, v121, s[48:51], 0 offen
    v_and_b32 v2, 7, v1
    v_lshlrev_b32 v25, 6, v2
    v_bfe_u32 v3, v1, 3, 1
    v_lshl_add_u32 v25, v3, 13, v25
    v_lshrrev_b32 v5, 4, v1
    v_lshrrev_b32 v2, 2, v2
    v_lshlrev_b32 v2, 1, v2
    v_xor_b32 v2, v2, v5
    v_lshl_add_u32 v25, v2, 4, v25
    s_lshl_b32 s56, s69, 12
    s_add_u32 s56, s56, 28672
    v_add_u32 v25, s56, v25
    v_add_u32 v24, 98304, v25
    v_lshlrev_b32 v120, 5, v5
    v_add_u32 v120, 24576, v120
    s_mul_i32 s56, s68, 6144
    s_add_u32 s56, s56, 45056
    v_add_u32 v122, s56, v124
    s_mov_b32 s62, 3207688728
    s_waitcnt lgkmcnt(0)
    s_barrier
    ds_read_b128 v[8:11], v24 offset:0
    ds_read_b128 v[12:15], v24 offset:16384
    ds_read_b128 v[16:19], v24 offset:512
    ds_read_b128 v[20:23], v24 offset:16896
    s_waitcnt lgkmcnt(2)
    v_mfma_f32_16x16x32_bf16 v[48:51], v[8:11], v[32:35], 0
    v_mfma_f32_16x16x32_bf16 v[52:55], v[8:11], v[36:39], 0
    v_mfma_f32_16x16x32_bf16 v[56:59], v[12:15], v[32:35], 0
    v_mfma_f32_16x16x32_bf16 v[60:63], v[12:15], v[36:39], 0
    ds_read_b128 v[8:11], v24 offset:1024
    ds_read_b128 v[12:15], v24 offset:17408
    s_waitcnt lgkmcnt(2)
    v_mfma_f32_16x16x32_bf16 v[48:51], v[16:19], v[40:43], v[48:51]
    v_mfma_f32_16x16x32_bf16 v[52:55], v[16:19], v[44:47], v[52:55]
    v_mfma_f32_16x16x32_bf16 v[56:59], v[20:23], v[40:43], v[56:59]
    v_mfma_f32_16x16x32_bf16 v[60:63], v[20:23], v[44:47], v[60:63]
    ds_read_b128 v[16:19], v24 offset:1536
    ds_read_b128 v[20:23], v24 offset:17920
    s_waitcnt lgkmcnt(2)
    v_mfma_f32_16x16x32_bf16 v[48:51], v[8:11], v[88:91], v[48:51]
    v_mfma_f32_16x16x32_bf16 v[52:55], v[8:11], v[92:95], v[52:55]
    v_mfma_f32_16x16x32_bf16 v[56:59], v[12:15], v[88:91], v[56:59]
    v_mfma_f32_16x16x32_bf16 v[60:63], v[12:15], v[92:95], v[60:63]
    ds_read_b128 v[8:11], v24 offset:2048
    ds_read_b128 v[12:15], v24 offset:18432
    s_waitcnt lgkmcnt(2)
    v_mfma_f32_16x16x32_bf16 v[48:51], v[16:19], v[96:99], v[48:51]
    v_mfma_f32_16x16x32_bf16 v[52:55], v[16:19], v[100:103], v[52:55]
    v_mfma_f32_16x16x32_bf16 v[56:59], v[20:23], v[96:99], v[56:59]
    v_mfma_f32_16x16x32_bf16 v[60:63], v[20:23], v[100:103], v[60:63]
    ds_read_b128 v[16:19], v24 offset:2560
    ds_read_b128 v[20:23], v24 offset:18944
    s_waitcnt lgkmcnt(2)
    v_mfma_f32_16x16x32_bf16 v[48:51], v[8:11], v[104:107], v[48:51]
    v_mfma_f32_16x16x32_bf16 v[52:55], v[8:11], v[108:111], v[52:55]
    v_mfma_f32_16x16x32_bf16 v[56:59], v[12:15], v[104:107], v[56:59]
    v_mfma_f32_16x16x32_bf16 v[60:63], v[12:15], v[108:111], v[60:63]
    ds_read_b128 v[8:11], v24 offset:3072
    ds_read_b128 v[12:15], v24 offset:19456
    s_waitcnt lgkmcnt(2)
    v_mfma_f32_16x16x32_bf16 v[48:51], v[16:19], v[112:115], v[48:51]
    v_mfma_f32_16x16x32_bf16 v[52:55], v[16:19], v[116:119], v[52:55]
    v_mfma_f32_16x16x32_bf16 v[56:59], v[20:23], v[112:115], v[56:59]
    v_mfma_f32_16x16x32_bf16 v[60:63], v[20:23], v[116:119], v[60:63]
    ds_read_b128 v[16:19], v24 offset:3584
    ds_read_b128 v[20:23], v24 offset:19968
    s_waitcnt lgkmcnt(2)
    v_mfma_f32_16x16x32_bf16 v[48:51], v[8:11], v[72:75], v[48:51]
    v_mfma_f32_16x16x32_bf16 v[52:55], v[8:11], v[76:79], v[52:55]
    v_mfma_f32_16x16x32_bf16 v[56:59], v[12:15], v[72:75], v[56:59]
    v_mfma_f32_16x16x32_bf16 v[60:63], v[12:15], v[76:79], v[60:63]
    s_waitcnt lgkmcnt(0)
    v_mfma_f32_16x16x32_bf16 v[48:51], v[16:19], v[80:83], v[48:51]
    v_mfma_f32_16x16x32_bf16 v[52:55], v[16:19], v[84:87], v[52:55]
    v_mfma_f32_16x16x32_bf16 v[56:59], v[20:23], v[80:83], v[56:59]
    v_mfma_f32_16x16x32_bf16 v[60:63], v[20:23], v[84:87], v[60:63]
    s_cmp_eq_u32 s69, 0
    s_cbranch_scc1 K2_G0
    s_nop 7
    ds_write_b128 v122, v[48:51] offset:0
    ds_write_b128 v122, v[52:55] offset:1024
    s_branch K2_G1
K2_G0:
    s_nop 7
    ds_write_b128 v122, v[56:59] offset:2048
    ds_write_b128 v122, v[60:63] offset:3072
K2_G1:
    s_waitcnt vmcnt(0)
    v_and_b32 v29, 0xffff0000, v28
    v_lshlrev_b32 v28, 16, v28
    s_mov_b64 exec, 1
    ds_add_rtn_u32 v2, v126, v123 offset:84
    s_mov_b64 exec, -1
    s_waitcnt lgkmcnt(0)
    v_readfirstlane_b32 s71, v2
    s_cmp_ge_u32 s71, 256
    s_cbranch_scc1 K2_NF2
    s_cmp_lg_u32 s71, 0
    s_cbranch_scc1 K2_SPF2
    s_mov_b64 exec, 0xff
    v_lshlrev_b32 v4, 7, v1
    s_mov_b32 s57, 0
K2_P2:
    buffer_load_dword v3, v4, s[80:83], 0 offen offset:2048 sc1
    s_add_u32 s57, s57, 1
    s_waitcnt vmcnt(0)
    v_cmp_eq_u32 vcc, 0, v3
    s_cbranch_vccz K2_P2D
    s_cmp_lt_u32 s57, 0x400000
    s_cbranch_scc1 K2_P2
K2_P2D:
    s_mov_b64 exec, -1
    ds_write_b32 v126, v123 offset:96
K2_SPF2:
    ds_read_b32 v2, v126 offset:96
    s_waitcnt lgkmcnt(0)
    v_readfirstlane_b32 s56, v2
    s_cmp_lt_u32 s56, 1
    s_cbranch_scc1 K2_SPF2
    s_lshr_b32 s56, s53, 1
    s_add_u32 s56, s56, 16
    s_lshl_b32 s56, s56, 14
    s_lshl_b32 s57, s71, 6
    s_add_u32 s56, s56, s57
    buffer_load_dwordx4 v[8:11], v124, s[36:39], s56 offen offset:0 sc1
    buffer_load_dwordx4 v[12:15], v124, s[36:39], s56 offen offset:1024 sc1
    buffer_load_dwordx4 v[16:19], v124, s[36:39], s56 offen offset:2048 sc1
    buffer_load_dwordx4 v[20:23], v124, s[36:39], s56 offen offset:3072 sc1
    s_add_u32 s57, s57, 28672
    v_add_u32 v125, s57, v124
    s_waitcnt vmcnt(3)
    ds_write_b128 v125, v[8:11] offset:0
    s_waitcnt vmcnt(2)
    ds_write_b128 v125, v[12:15] offset:1024
    s_waitcnt vmcnt(1)
    ds_write_b128 v125, v[16:19] offset:2048
    s_waitcnt vmcnt(0)
    ds_write_b128 v125, v[20:23] offset:3072
K2_NF2:
    s_waitcnt lgkmcnt(0)
    s_barrier
    s_cmp_lg_u32 s70, 0
    s_cbranch_scc1 K2_IDLE2
    ds_read_b128 v[8:11], v25 offset:0
    ds_read_b128 v[12:15], v25 offset:512
    ds_read_b128 v[16:19], v25 offset:1024
    ds_read_b128 v[20:23], v25 offset:1536
    s_waitcnt lgkmcnt(3)
    v_mfma_f32_16x16x32_bf16 v[64:67], v[8:11], v[32:35], 0
    v_mfma_f32_16x16x32_bf16 v[68:71], v[8:11], v[36:39], 0
    ds_read_b128 v[8:11], v25 offset:2048
    s_waitcnt lgkmcnt(3)
    v_mfma_f32_16x16x32_bf16 v[64:67], v[12:15], v[40:43], v[64:67]
    v_mfma_f32_16x16x32_bf16 v[68:71], v[12:15], v[44:47], v[68:71]
    ds_read_b128 v[12:15], v25 offset:2560
    s_waitcnt lgkmcnt(3)
    v_mfma_f32_16x16x32_bf16 v[64:67], v[16:19], v[88:91], v[64:67]
    v_mfma_f32_16x16x32_bf16 v[68:71], v[16:19], v[92:95], v[68:71]
    ds_read_b128 v[16:19], v25 offset:3072
    s_waitcnt lgkmcnt(3)
    v_mfma_f32_16x16x32_bf16 v[64:67], v[20:23], v[96:99], v[64:67]
    v_mfma_f32_16x16x32_bf16 v[68:71], v[20:23], v[100:103], v[68:71]
    ds_read_b128 v[20:23], v25 offset:3584
    s_waitcnt lgkmcnt(3)
    v_mfma_f32_16x16x32_bf16 v[64:67], v[8:11], v[104:107], v[64:67]
    v_mfma_f32_16x16x32_bf16 v[68:71], v[8:11], v[108:111], v[68:71]
    s_waitcnt lgkmcnt(2)
    v_mfma_f32_16x16x32_bf16 v[64:67], v[12:15], v[112:115], v[64:67]
    v_mfma_f32_16x16x32_bf16 v[68:71], v[12:15], v[116:119], v[68:71]
    s_waitcnt lgkmcnt(1)
    v_mfma_f32_16x16x32_bf16 v[64:67], v[16:19], v[72:75], v[64:67]
    v_mfma_f32_16x16x32_bf16 v[68:71], v[16:19], v[76:79], v[68:71]
    s_waitcnt lgkmcnt(0)
    v_mfma_f32_16x16x32_bf16 v[64:67], v[20:23], v[80:83], v[64:67]
    v_mfma_f32_16x16x32_bf16 v[68:71], v[20:23], v[84:87], v[68:71]
    s_cmp_eq_u32 s69, 0
    s_cbranch_scc0 K2_O1
    s_lshr_b32 s56, s53, 0
    s_add_u32 s56, s56, 0
    s_lshl_b32 s56, s56, 7
    v_add_u32 v2, s56, v120
    ds_read_b128 v[8:11], v2
    ds_read_b128 v[12:15], v2 offset:16
    ds_read_b128 v[16:19], v122 offset:0
    ds_read_b128 v[20:23], v122 offset:1024
    s_waitcnt lgkmcnt(2)
    v_lshrrev_b32 v8, 16, v8
    v_cvt_f32_u32 v9, v9
    v_lshl_add_u32 v8, v8, 9, v121
    v_lshrrev_b32 v10, 16, v10
    v_cvt_f32_u32 v11, v11
    v_lshl_add_u32 v10, v10, 9, v121
    v_lshrrev_b32 v12, 16, v12
    v_cvt_f32_u32 v13, v13
    v_lshl_add_u32 v12, v12, 9, v121
    v_lshrrev_b32 v14, 16, v14
    v_cvt_f32_u32 v15, v15
    v_lshl_add_u32 v14, v14, 9, v121
    s_waitcnt lgkmcnt(0)
    v_add_f32 v48, v48, v16
    v_add_f32 v49, v49, v17
    v_add_f32 v50, v50, v18
    v_add_f32 v51, v51, v19
    v_add_f32 v52, v52, v20
    v_add_f32 v53, v53, v21
    v_add_f32 v54, v54, v22
    v_add_f32 v55, v55, v23
    v_mul_f32 v2, v9, v28
    v_mul_f32 v3, v9, v29
    v_fma_f32 v48, v48, s62, v2
    v_fma_f32 v52, v52, s62, v3
    v_cvt_pk_bf16_f32 v48, v48, v52
    buffer_store_dword v48, v8, s[76:79], 0 offen sc1
    v_mul_f32 v2, v11, v28
    v_mul_f32 v3, v11, v29
    v_fma_f32 v49, v49, s62, v2
    v_fma_f32 v53, v53, s62, v3
    v_cvt_pk_bf16_f32 v49, v49, v53
    buffer_store_dword v49, v10, s[76:79], 0 offen sc1
    v_mul_f32 v2, v13, v28
    v_mul_f32 v3, v13, v29
    v_fma_f32 v50, v50, s62, v2
    v_fma_f32 v54, v54, s62, v3
    v_cvt_pk_bf16_f32 v50, v50, v54
    buffer_store_dword v50, v12, s[76:79], 0 offen sc1
    v_mul_f32 v2, v15, v28
    v_mul_f32 v3, v15, v29
    v_fma_f32 v51, v51, s62, v2
    v_fma_f32 v55, v55, s62, v3
    v_cvt_pk_bf16_f32 v51, v51, v55
    buffer_store_dword v51, v14, s[76:79], 0 offen sc1
    s_barrier
    s_lshr_b32 s56, s53, 1
    s_add_u32 s56, s56, 16
    s_lshl_b32 s56, s56, 7
    v_add_u32 v2, s56, v120
    ds_read_b128 v[8:11], v2
    ds_read_b128 v[12:15], v2 offset:16
    ds_read_b128 v[16:19], v122 offset:4096
    ds_read_b128 v[20:23], v122 offset:5120
    s_waitcnt lgkmcnt(2)
    v_lshrrev_b32 v8, 16, v8
    v_cvt_f32_u32 v9, v9
    v_lshl_add_u32 v8, v8, 9, v121
    v_lshrrev_b32 v10, 16, v10
    v_cvt_f32_u32 v11, v11
    v_lshl_add_u32 v10, v10, 9, v121
    v_lshrrev_b32 v12, 16, v12
    v_cvt_f32_u32 v13, v13
    v_lshl_add_u32 v12, v12, 9, v121
    v_lshrrev_b32 v14, 16, v14
    v_cvt_f32_u32 v15, v15
    v_lshl_add_u32 v14, v14, 9, v121
    s_waitcnt lgkmcnt(0)
    v_add_f32 v64, v64, v16
    v_add_f32 v65, v65, v17
    v_add_f32 v66, v66, v18
    v_add_f32 v67, v67, v19
    v_add_f32 v68, v68, v20
    v_add_f32 v69, v69, v21
    v_add_f32 v70, v70, v22
    v_add_f32 v71, v71, v23
    v_mul_f32 v2, v9, v28
    v_mul_f32 v3, v9, v29
    v_fma_f32 v64, v64, s62, v2
    v_fma_f32 v68, v68, s62, v3
    v_cvt_pk_bf16_f32 v64, v64, v68
    buffer_store_dword v64, v8, s[76:79], 0 offen sc1
    v_mul_f32 v2, v11, v28
    v_mul_f32 v3, v11, v29
    v_fma_f32 v65, v65, s62, v2
    v_fma_f32 v69, v69, s62, v3
    v_cvt_pk_bf16_f32 v65, v65, v69
    buffer_store_dword v65, v10, s[76:79], 0 offen sc1
    v_mul_f32 v2, v13, v28
    v_mul_f32 v3, v13, v29
    v_fma_f32 v66, v66, s62, v2
    v_fma_f32 v70, v70, s62, v3
    v_cvt_pk_bf16_f32 v66, v66, v70
    buffer_store_dword v66, v12, s[76:79], 0 offen sc1
    v_mul_f32 v2, v15, v28
    v_mul_f32 v3, v15, v29
    v_fma_f32 v67, v67, s62, v2
    v_fma_f32 v71, v71, s62, v3
    v_cvt_pk_bf16_f32 v67, v67, v71
    buffer_store_dword v67, v14, s[76:79], 0 offen sc1
    s_branch K2_OX
K2_O1:
    s_nop 7
    ds_write_b128 v122, v[64:67] offset:4096
    ds_write_b128 v122, v[68:71] offset:5120
    s_waitcnt lgkmcnt(0)
    s_barrier
    s_lshr_b32 s56, s53, 0
    s_add_u32 s56, s56, 8
    s_lshl_b32 s56, s56, 7
    v_add_u32 v2, s56, v120
    ds_read_b128 v[8:11], v2
    ds_read_b128 v[12:15], v2 offset:16
    ds_read_b128 v[16:19], v122 offset:2048
    ds_read_b128 v[20:23], v122 offset:3072
    s_waitcnt lgkmcnt(2)
    v_lshrrev_b32 v8, 16, v8
    v_cvt_f32_u32 v9, v9
    v_lshl_add_u32 v8, v8, 9, v121
    v_lshrrev_b32 v10, 16, v10
    v_cvt_f32_u32 v11, v11
    v_lshl_add_u32 v10, v10, 9, v121
    v_lshrrev_b32 v12, 16, v12
    v_cvt_f32_u32 v13, v13
    v_lshl_add_u32 v12, v12, 9, v121
    v_lshrrev_b32 v14, 16, v14
    v_cvt_f32_u32 v15, v15
    v_lshl_add_u32 v14, v14, 9, v121
    s_waitcnt lgkmcnt(0)
    v_add_f32 v56, v56, v16
    v_add_f32 v57, v57, v17
    v_add_f32 v58, v58, v18
    v_add_f32 v59, v59, v19
    v_add_f32 v60, v60, v20
    v_add_f32 v61, v61, v21
    v_add_f32 v62, v62, v22
    v_add_f32 v63, v63, v23
    v_mul_f32 v2, v9, v28
    v_mul_f32 v3, v9, v29
    v_fma_f32 v56, v56, s62, v2
    v_fma_f32 v60, v60, s62, v3
    v_cvt_pk_bf16_f32 v56, v56, v60
    buffer_store_dword v56, v8, s[76:79], 0 offen sc1
    v_mul_f32 v2, v11, v28
    v_mul_f32 v3, v11, v29
    v_fma_f32 v57, v57, s62, v2
    v_fma_f32 v61, v61, s62, v3
    v_cvt_pk_bf16_f32 v57, v57, v61
    buffer_store_dword v57, v10, s[76:79], 0 offen sc1
    v_mul_f32 v2, v13, v28
    v_mul_f32 v3, v13, v29
    v_fma_f32 v58, v58, s62, v2
    v_fma_f32 v62, v62, s62, v3
    v_cvt_pk_bf16_f32 v58, v58, v62
    buffer_store_dword v58, v12, s[76:79], 0 offen sc1
    v_mul_f32 v2, v15, v28
    v_mul_f32 v3, v15, v29
    v_fma_f32 v59, v59, s62, v2
    v_fma_f32 v63, v63, s62, v3
    v_cvt_pk_bf16_f32 v59, v59, v63
    buffer_store_dword v59, v14, s[76:79], 0 offen sc1
    s_branch K2_OX
K2_IDLE2:
    s_cmp_eq_u32 s69, 0
    s_cbranch_scc1 K2_IDLE3
    s_lshr_b32 s56, s53, 0
    s_add_u32 s56, s56, 8
    s_lshl_b32 s56, s56, 7
    v_add_u32 v2, s56, v120
    ds_read_b128 v[8:11], v2
    ds_read_b128 v[12:15], v2 offset:16
    ds_read_b128 v[16:19], v122 offset:2048
    ds_read_b128 v[20:23], v122 offset:3072
    s_waitcnt lgkmcnt(2)
    v_lshrrev_b32 v8, 16, v8
    v_cvt_f32_u32 v9, v9
    v_lshl_add_u32 v8, v8, 9, v121
    v_lshrrev_b32 v10, 16, v10
    v_cvt_f32_u32 v11, v11
    v_lshl_add_u32 v10, v10, 9, v121
    v_lshrrev_b32 v12, 16, v12
    v_cvt_f32_u32 v13, v13
    v_lshl_add_u32 v12, v12, 9, v121
    v_lshrrev_b32 v14, 16, v14
    v_cvt_f32_u32 v15, v15
    v_lshl_add_u32 v14, v14, 9, v121
    s_waitcnt lgkmcnt(0)
    v_add_f32 v56, v56, v16
    v_add_f32 v57, v57, v17
    v_add_f32 v58, v58, v18
    v_add_f32 v59, v59, v19
    v_add_f32 v60, v60, v20
    v_add_f32 v61, v61, v21
    v_add_f32 v62, v62, v22
    v_add_f32 v63, v63, v23
    v_mul_f32 v2, v9, v28
    v_mul_f32 v3, v9, v29
    v_fma_f32 v56, v56, s62, v2
    v_fma_f32 v60, v60, s62, v3
    v_cvt_pk_bf16_f32 v56, v56, v60
    buffer_store_dword v56, v8, s[76:79], 0 offen sc1
    v_mul_f32 v2, v11, v28
    v_mul_f32 v3, v11, v29
    v_fma_f32 v57, v57, s62, v2
    v_fma_f32 v61, v61, s62, v3
    v_cvt_pk_bf16_f32 v57, v57, v61
    buffer_store_dword v57, v10, s[76:79], 0 offen sc1
    v_mul_f32 v2, v13, v28
    v_mul_f32 v3, v13, v29
    v_fma_f32 v58, v58, s62, v2
    v_fma_f32 v62, v62, s62, v3
    v_cvt_pk_bf16_f32 v58, v58, v62
    buffer_store_dword v58, v12, s[76:79], 0 offen sc1
    v_mul_f32 v2, v15, v28
    v_mul_f32 v3, v15, v29
    v_fma_f32 v59, v59, s62, v2
    v_fma_f32 v63, v63, s62, v3
    v_cvt_pk_bf16_f32 v59, v59, v63
    buffer_store_dword v59, v14, s[76:79], 0 offen sc1
    s_barrier
    s_branch K2_OX
K2_IDLE3:
    s_lshr_b32 s56, s53, 0
    s_add_u32 s56, s56, 0
    s_lshl_b32 s56, s56, 7
    v_add_u32 v2, s56, v120
    ds_read_b128 v[8:11], v2
    ds_read_b128 v[12:15], v2 offset:16
    ds_read_b128 v[16:19], v122 offset:0
    ds_read_b128 v[20:23], v122 offset:1024
    s_waitcnt lgkmcnt(2)
    v_lshrrev_b32 v8, 16, v8
    v_cvt_f32_u32 v9, v9
    v_lshl_add_u32 v8, v8, 9, v121
    v_lshrrev_b32 v10, 16, v10
    v_cvt_f32_u32 v11, v11
    v_lshl_add_u32 v10, v10, 9, v121
    v_lshrrev_b32 v12, 16, v12
    v_cvt_f32_u32 v13, v13
    v_lshl_add_u32 v12, v12, 9, v121
    v_lshrrev_b32 v14, 16, v14
    v_cvt_f32_u32 v15, v15
    v_lshl_add_u32 v14, v14, 9, v121
    s_waitcnt lgkmcnt(0)
    v_add_f32 v48, v48, v16
    v_add_f32 v49, v49, v17
    v_add_f32 v50, v50, v18
    v_add_f32 v51, v51, v19
    v_add_f32 v52, v52, v20
    v_add_f32 v53, v53, v21
    v_add_f32 v54, v54, v22
    v_add_f32 v55, v55, v23
    v_mul_f32 v2, v9, v28
    v_mul_f32 v3, v9, v29
    v_fma_f32 v48, v48, s62, v2
    v_fma_f32 v52, v52, s62, v3
    v_cvt_pk_bf16_f32 v48, v48, v52
    buffer_store_dword v48, v8, s[76:79], 0 offen sc1
    v_mul_f32 v2, v11, v28
    v_mul_f32 v3, v11, v29
    v_fma_f32 v49, v49, s62, v2
    v_fma_f32 v53, v53, s62, v3
    v_cvt_pk_bf16_f32 v49, v49, v53
    buffer_store_dword v49, v10, s[76:79], 0 offen sc1
    v_mul_f32 v2, v13, v28
    v_mul_f32 v3, v13, v29
    v_fma_f32 v50, v50, s62, v2
    v_fma_f32 v54, v54, s62, v3
    v_cvt_pk_bf16_f32 v50, v50, v54
    buffer_store_dword v50, v12, s[76:79], 0 offen sc1
    v_mul_f32 v2, v15, v28
    v_mul_f32 v3, v15, v29
    v_fma_f32 v51, v51, s62, v2
    v_fma_f32 v55, v55, s62, v3
    v_cvt_pk_bf16_f32 v51, v51, v55
    buffer_store_dword v51, v14, s[76:79], 0 offen sc1
    s_barrier
K2_OX:
    s_endpgm
K2_IWB:
    ds_read_b32 v2, v126 offset:108
    s_waitcnt lgkmcnt(0)
    v_readfirstlane_b32 s56, v2
    s_cmp_lt_u32 s56, 384
    s_cbranch_scc1 K2_IWB
    s_branch K2_IWBD
K2_CNT3:
    s_cmp_eq_u32 s84, 0
    s_cbranch_scc1 K2_CNT3D
    s_waitcnt vmcnt(2)
    s_mov_b64 s[86:87], exec
    s_mov_b64 exec, 1
    s_lshl_b32 s56, s84, 2
    v_add_u32 v2, s56, v126
    ds_add_rtn_u32 v2, v2, v123 offset:64
    s_lshl_b32 s56, s84, 3
    s_add_u32 s56, s56, s53
    s_sub_u32 s56, s56, 8
    s_lshl_b32 s56, s56, 7
    v_mov_b32 v3, s56
    s_mov_b32 s84, 0
    s_waitcnt lgkmcnt(0)
    v_readfirstlane_b32 s56, v2
    s_cmp_lg_u32 s56, 960
    s_cbranch_scc1 K2_CEE
    buffer_store_dword v123, v3, s[80:83], 0 offen sc1
K2_CEE:
    s_mov_b64 exec, s[86:87]
    s_branch K2_CNT3D
K2_PRE:
    s_lshr_b32 s56, s59, 1
    s_lshl_b32 s56, s56, 15
    s_and_b32 s57, s59, 1
    s_mul_i32 s57, s57, 6144
    s_add_u32 s56, s56, s57
    s_mul_i32 s57, s59, 6144
    s_add_u32 m0, s57, 28672
    s_nop 0
    buffer_load_dwordx4 v124, s[44:47], s56 offen offset:0 lds
    buffer_load_dwordx4 v124, s[44:47], s56 offen offset:1024 lds
    buffer_load_dwordx4 v124, s[44:47], s56 offen offset:2048 lds
    buffer_load_dwordx4 v124, s[44:47], s56 offen offset:3072 lds
    s_add_u32 m0, s57, 32768
    s_add_u32 s56, s56, 4096
    buffer_load_dwordx4 v124, s[44:47], s56 offen offset:0 lds
    buffer_load_dwordx4 v124, s[44:47], s56 offen offset:1024 lds
    s_branch K2_PRED
K2_OOL0:
    v_mov_b32 v48, 0
    v_mov_b32 v56, 1.0
    v_mov_b32 v49, 0
    v_mov_b32 v57, 1.0
    v_mov_b32 v50, 0
    v_mov_b32 v58, 1.0
    v_mov_b32 v51, 0
    v_mov_b32 v59, 1.0
    v_mov_b32 v52, 0
    v_mov_b32 v60, 1.0
    v_mov_b32 v53, 0
    v_mov_b32 v61, 1.0
    v_mov_b32 v54, 0
    v_mov_b32 v62, 1.0
    v_mov_b32 v55, 0
    v_mov_b32 v63, 1.0
    s_cmp_le_u32 s59, 0
    s_cbranch_scc1 K2_FIN
    v_cmpx_lt_u32 vcc, 0, v27
    s_nop 3
    s_branch K2_S0
K2_OOL1:
    v_mov_b32 v48, v88
    v_mov_b32 v49, v89
    v_mov_b32 v50, v90
    v_mov_b32 v51, v91
    v_mov_b32 v52, v92
    v_mov_b32 v53, v93
    v_mov_b32 v54, v94
    v_mov_b32 v55, v95
    s_cmp_le_u32 s59, 1
    s_cbranch_scc1 K2_FIN
    v_cmpx_lt_u32 vcc, 1, v27
    s_nop 3
    s_branch K2_S1
K2_OOL2:
    s_cmp_le_u32 s59, 2
    s_cbranch_scc1 K2_FIN
    v_cmpx_lt_u32 vcc, 2, v27
    s_nop 3
    s_branch K2_S2
K2_OOL3:
    s_cmp_le_u32 s59, 3
    s_cbranch_scc1 K2_FIN
    v_cmpx_lt_u32 vcc, 3, v27
    s_nop 3
    s_branch K2_S3
K2_OOL4:
    s_cmp_le_u32 s59, 4
    s_cbranch_scc1 K2_FIN
    v_cmpx_lt_u32 vcc, 4, v27
    s_nop 3
    s_branch K2_S4
K2_OOL5:
    s_cmp_le_u32 s59, 5
    s_cbranch_scc1 K2_FIN
    v_cmpx_lt_u32 vcc, 5, v27
    s_nop 3
    s_branch K2_S5
K2_OOL6:
    s_cmp_le_u32 s59, 6
    s_cbranch_scc1 K2_FIN
    v_cmpx_lt_u32 vcc, 6, v27
    s_nop 3
    s_branch K2_S6
K2_OOL7:
    s_cmp_le_u32 s59, 7
    s_cbranch_scc1 K2_FIN
    v_cmpx_lt_u32 vcc, 7, v27
    s_nop 3
    s_branch K2_S7
K2_OOL8:
    s_cmp_le_u32 s59, 8
    s_cbranch_scc1 K2_FIN
    v_cmpx_lt_u32 vcc, 8, v27
    s_nop 3
    s_branch K2_S8
K2_OOL9:
    s_cmp_le_u32 s59, 9
    s_cbranch_scc1 K2_FIN
    v_cmpx_lt_u32 vcc, 9, v27
    s_nop 3
    s_branch K2_S9
K2_OOL10:
    s_cmp_le_u32 s59, 10
    s_cbranch_scc1 K2_FIN
    v_cmpx_lt_u32 vcc, 10, v27
    s_nop 3
    s_branch K2_S10
K2_OOL11:
    s_cmp_le_u32 s59, 11
    s_cbranch_scc1 K2_FIN
    v_cmpx_lt_u32 vcc, 11, v27
    s_nop 3
    s_branch K2_S11
K2_OOL12:
    s_cmp_le_u32 s59, 12
    s_cbranch_scc1 K2_FIN
    v_cmpx_lt_u32 vcc, 12, v27
    s_nop 3
    s_branch K2_S12
K2_OOL13:
    s_cmp_le_u32 s59, 13
    s_cbranch_scc1 K2_FIN
    v_cmpx_lt_u32 vcc, 13, v27
    s_nop 3
    s_branch K2_S13
K2_OOL14:
    s_cmp_le_u32 s59, 14
    s_cbranch_scc1 K2_FIN
    v_cmpx_lt_u32 vcc, 14, v27
    s_nop 3
    s_branch K2_S14
K2_OOL15:
    s_cmp_le_u32 s59, 15
    s_cbranch_scc1 K2_FIN
    v_cmpx_lt_u32 vcc, 15, v27
    s_nop 3
    s_branch K2_S15
K2_OOL16:
    s_cmp_le_u32 s59, 16
    s_cbranch_scc1 K2_FIN
    v_cmpx_lt_u32 vcc, 16, v27
    s_nop 3
    s_branch K2_S16
K2_OOL17:
    s_cmp_le_u32 s59, 17
    s_cbranch_scc1 K2_FIN
    v_cmpx_lt_u32 vcc, 17, v27
    s_nop 3
    s_branch K2_S17
K2_OOL18:
    s_cmp_le_u32 s59, 18
    s_cbranch_scc1 K2_FIN
    v_cmpx_lt_u32 vcc, 18, v27
    s_nop 3
    s_branch K2_S18
K2_OOL19:
    s_cmp_le_u32 s59, 19
    s_cbranch_scc1 K2_FIN
    v_cmpx_lt_u32 vcc, 19, v27
    s_nop 3
    s_branch K2_S19
K2_OOL20:
    s_cmp_le_u32 s59, 20
    s_cbranch_scc1 K2_FIN
    v_cmpx_lt_u32 vcc, 20, v27
    s_nop 3
    s_branch K2_S20
K2_OOL21:
    s_cmp_le_u32 s59, 21
    s_cbranch_scc1 K2_FIN
    v_cmpx_lt_u32 vcc, 21, v27
    s_nop 3
    s_branch K2_S21
K2_OOL22:
    s_cmp_le_u32 s59, 22
    s_cbranch_scc1 K2_FIN
    v_cmpx_lt_u32 vcc, 22, v27
    s_nop 3
    s_branch K2_S22
K2_OOL23:
    s_cmp_le_u32 s59, 23
    s_cbranch_scc1 K2_FIN
    v_cmpx_lt_u32 vcc, 23, v27
    s_nop 3
    s_branch K2_S23
K2_OOL24:
    s_cmp_le_u32 s59, 24
    s_cbranch_scc1 K2_FIN
    v_cmpx_lt_u32 vcc, 24, v27
    s_nop 3
    s_branch K2_S24
K2_OOL25:
    s_cmp_le_u32 s59, 25
    s_cbranch_scc1 K2_FIN
    v_cmpx_lt_u32 vcc, 25, v27
    s_nop 3
    s_branch K2_S25
K2_OOL26:
    s_cmp_le_u32 s59, 26
    s_cbranch_scc1 K2_FIN
    v_cmpx_lt_u32 vcc, 26, v27
    s_nop 3
    s_branch K2_S26
K2_OOL27:
    s_cmp_le_u32 s59, 27
    s_cbranch_scc1 K2_FIN
    v_cmpx_lt_u32 vcc, 27, v27
    s_nop 3
    s_branch K2_S27
K2_OOL28:
    s_cmp_le_u32 s59, 28
    s_cbranch_scc1 K2_FIN
    v_cmpx_lt_u32 vcc, 28, v27
    s_nop 3
    s_branch K2_S28
K2_OOL29:
    s_cmp_le_u32 s59, 29
    s_cbranch_scc1 K2_FIN
    v_cmpx_lt_u32 vcc, 29, v27
    s_nop 3
    s_branch K2_S29
K2_OOL30:
    s_cmp_le_u32 s59, 30
    s_cbranch_scc1 K2_FIN
    v_cmpx_lt_u32 vcc, 30, v27
    s_nop 3
    s_branch K2_S30
K2_OOL31:
    s_cmp_le_u32 s59, 31
    s_cbranch_scc1 K2_FIN
    v_cmpx_lt_u32 vcc, 31, v27
    s_nop 3
    s_branch K2_S31
K2_OOL32:
    s_cmp_le_u32 s59, 32
    s_cbranch_scc1 K2_FIN
    v_cmpx_lt_u32 vcc, 32, v27
    s_nop 3
    s_branch K2_S32
K2_OOL33:
    s_cmp_le_u32 s59, 33
    s_cbranch_scc1 K2_FIN
    v_cmpx_lt_u32 vcc, 33, v27
    s_nop 3
    s_branch K2_S33
K2_OOL34:
    s_cmp_le_u32 s59, 34
    s_cbranch_scc1 K2_FIN
    v_cmpx_lt_u32 vcc, 34, v27
    s_nop 3
    s_branch K2_S34
K2_OOL35:
    s_cmp_le_u32 s59, 35
    s_cbranch_scc1 K2_FIN
    v_cmpx_lt_u32 vcc, 35, v27
    s_nop 3
    s_branch K2_S35
K2_OOL36:
    s_cmp_le_u32 s59, 36
    s_cbranch_scc1 K2_FIN
    v_cmpx_lt_u32 vcc, 36, v27
    s_nop 3
    s_branch K2_S36
K2_OOL37:
    s_cmp_le_u32 s59, 37
    s_cbranch_scc1 K2_FIN
    v_cmpx_lt_u32 vcc, 37, v27
    s_nop 3
    s_branch K2_S37
K2_OOL38:
    s_cmp_le_u32 s59, 38
    s_cbranch_scc1 K2_FIN
    v_cmpx_lt_u32 vcc, 38, v27
    s_nop 3
    s_branch K2_S38
K2_OOL39:
    s_cmp_le_u32 s59, 39
    s_cbranch_scc1 K2_FIN
    v_cmpx_lt_u32 vcc, 39, v27
    s_nop 3
    s_branch K2_S39
K2_OOL40:
    s_cmp_le_u32 s59, 40
    s_cbranch_scc1 K2_FIN
    v_cmpx_lt_u32 vcc, 40, v27
    s_nop 3
    s_branch K2_S40
K2_OOL41:
    s_cmp_le_u32 s59, 41
    s_cbranch_scc1 K2_FIN
    v_cmpx_lt_u32 vcc, 41, v27
    s_nop 3
    s_branch K2_S41
K2_OOL42:
    s_cmp_le_u32 s59, 42
    s_cbranch_scc1 K2_FIN
    v_cmpx_lt_u32 vcc, 42, v27
    s_nop 3
    s_branch K2_S42
K2_OOL43:
    s_cmp_le_u32 s59, 43
    s_cbranch_scc1 K2_FIN
    v_cmpx_lt_u32 vcc, 43, v27
    s_nop 3
    s_branch K2_S43
K2_OOL44:
    s_cmp_le_u32 s59, 44
    s_cbranch_scc1 K2_FIN
    v_cmpx_lt_u32 vcc, 44, v27
    s_nop 3
    s_branch K2_S44
K2_OOL45:
    s_cmp_le_u32 s59, 45
    s_cbranch_scc1 K2_FIN
    v_cmpx_lt_u32 vcc, 45, v27
    s_nop 3
    s_branch K2_S45
K2_OOL46:
    s_cmp_le_u32 s59, 46
    s_cbranch_scc1 K2_FIN
    v_cmpx_lt_u32 vcc, 46, v27
    s_nop 3
    s_branch K2_S46
K2_OOL47:
    s_cmp_le_u32 s59, 47
    s_cbranch_scc1 K2_FIN
    v_cmpx_lt_u32 vcc, 47, v27
    s_nop 3
    s_branch K2_S47
K2_SAFE:
    s_waitcnt vmcnt(0) lgkmcnt(0)
    s_mov_b32 s56, 0
    s_mov_b32 s30, 10000
    v_mov_b32 v48, 0
    v_mov_b32 v49, 0
    v_mov_b32 v50, 0
    v_mov_b32 v51, 0
    v_mov_b32 v52, 0
    v_mov_b32 v53, 0
    v_mov_b32 v54, 0
    v_mov_b32 v55, 0
K2_SAFE_L:
    s_cmp_ge_u32 s56, s59
    s_cbranch_scc1 K2_SAFE_E
    v_cmpx_lt_u32 vcc, s56, v27
    ds_read_u16 v16, v25 offset:0
    ds_read_u16 v12, v26 offset:0
    s_waitcnt lgkmcnt(0)
    buffer_load_dwordx4 v[72:75], v[16:17], s[28:31], 0 idxen offen
    v_lshlrev_b64 v[14:15], v24, v[12:13]
    v_add_u32 v25, 32, v25
    v_add_u32 v26, 32, v26
    s_nop 1
    v_mfma_f32_32x32x8_bf16 v[88:103], v[8:9], v[14:15], v[32:47]
    s_nop 9
    s_waitcnt vmcnt(0)
    v_mfma_f32_4x4x4_16b_bf16 v[88:91], v[6:7], v[72:73], v[88:91]
    v_mfma_f32_4x4x4_16b_bf16 v[92:95], v[6:7], v[74:75], v[92:95]
    s_nop 4
    v_exp_f32 v64, v88
    v_exp_f32 v65, v89
    v_exp_f32 v66, v90
    v_exp_f32 v67, v91
    v_exp_f32 v68, v92
    v_exp_f32 v69, v93
    v_exp_f32 v70, v94
    v_exp_f32 v71, v95
    v_pk_add_f32 v[64:65], v[64:65], s[66:67]
    v_pk_add_f32 v[66:67], v[66:67], s[66:67]
    v_pk_add_f32 v[68:69], v[68:69], s[66:67]
    v_pk_add_f32 v[70:71], v[70:71], s[66:67]
    v_rcp_f32 v64, v64
    v_rcp_f32 v65, v65
    v_rcp_f32 v66, v66
    v_rcp_f32 v67, v67
    v_rcp_f32 v68, v68
    v_rcp_f32 v69, v69
    v_rcp_f32 v70, v70
    v_rcp_f32 v71, v71
    s_nop 0
    v_pk_fma_f32 v[48:49], v[88:89], v[64:65], v[48:49]
    v_pk_fma_f32 v[50:51], v[90:91], v[66:67], v[50:51]
    v_pk_fma_f32 v[52:53], v[92:93], v[68:69], v[52:53]
    v_pk_fma_f32 v[54:55], v[94:95], v[70:71], v[54:55]
    s_add_u32 s56, s56, 1
    s_branch K2_SAFE_L
K2_SAFE_E:
    s_mov_b64 exec, -1
    v_mov_b32 v56, 1.0
    v_mov_b32 v57, 1.0
    v_mov_b32 v58, 1.0
    v_mov_b32 v59, 1.0
    v_mov_b32 v60, 1.0
    v_mov_b32 v61, 1.0
    v_mov_b32 v62, 1.0
    v_mov_b32 v63, 1.0
    s_branch K2_NEXT
K2_SLOW:
    s_lshr_b32 s56, s52, 1
    s_lshl_b32 s56, s56, 15
    s_and_b32 s57, s52, 1
    s_mul_i32 s57, s57, 6144
    s_add_u32 s56, s56, s57
    s_mul_i32 s57, s52, 6144
    s_add_u32 m0, s57, 28672
    s_nop 0
    buffer_load_dwordx4 v124, s[44:47], s56 offen offset:0 lds
    buffer_load_dwordx4 v124, s[44:47], s56 offen offset:1024 lds
    buffer_load_dwordx4 v124, s[44:47], s56 offen offset:2048 lds
    buffer_load_dwordx4 v124, s[44:47], s56 offen offset:3072 lds
    s_add_u32 m0, s57, 32768
    s_add_u32 s56, s56, 4096
    buffer_load_dwordx4 v124, s[44:47], s56 offen offset:0 lds
    buffer_load_dwordx4 v124, s[44:47], s56 offen offset:1024 lds
    s_mov_b32 s58, s52
    v_cmp_gt_u32 vcc, 320, v0
    v_lshlrev_b32 v2, 16, v0
    v_mov_b32 v3, 0
    v_lshlrev_b32 v4, 3, v0
    s_and_saveexec_b64 s[70:71], vcc
    ds_write_b64 v4, v[2:3] offset:24576
    s_mov_b64 exec, -1
    s_waitcnt lgkmcnt(0)
    s_barrier
    s_add_u32 s40, s12, 524288
    s_addc_u32 s41, s13, 0
    s_and_b32 s41, s41, 0xffff
    s_mov_b32 s42, 1024
    s_mov_b32 s43, 0x20000
    v_and_b32 v2, 1, v1
    v_lshlrev_b32 v2, 6, v2
    v_and_b32 v3, 62, v1
    v_add_u32 v2, v2, v3
    s_lshl_b32 s57, s53, 7
    buffer_load_ushort v32, v2, s[40:43], s57 offen
    s_waitcnt vmcnt(0)
    v_lshlrev_b32 v32, 16, v32
    v_mul_f32 v32, s62, v32
    s_mov_b32 s24, s10
    s_and_b32 s25, s11, 0xffff
    s_mov_b32 s26, 640000
    s_mov_b32 s27, 0x20000
    s_mov_b32 s48, s8
    s_and_b32 s49, s9, 0xffff
    s_mov_b32 s50, 640000
    s_mov_b32 s51, 0x20000
    s_mov_b32 s40, s6
    s_and_b32 s41, s7, 0xffff
    s_mov_b32 s42, 320000
    s_mov_b32 s43, 0x20000
    v_lshlrev_b32 v17, 1, v1
    v_lshlrev_b32 v4, 4, v1
    v_lshlrev_b32 v5, 3, v1
    v_lshrrev_b32 v48, 5, v1
    v_lshlrev_b32 v48, 9, v48
    v_and_b32 v2, 31, v1
    v_lshl_add_u32 v48, v2, 1, v48
K2_SLOW_N:
    s_cmp_ge_u32 s58, s55
    s_cbranch_scc1 K2_SLOW_E
    s_mul_i32 s68, s54, 313
    s_add_u32 s68, s68, s58
    v_mov_b32 v16, s58
    buffer_load_ushort v33, v[16:17], s[32:35], 0 idxen offen
    v_mov_b32 v34, 0
    s_mov_b32 s69, 0
    s_mov_b32 s70, 0
    s_waitcnt vmcnt(0)
    v_lshlrev_b32 v33, 16, v33
K2_SLOW_C:
    s_lshl_b32 s56, s69, 2
    s_lshl_b32 s57, s69, 1
    buffer_load_dwordx4 v[36:39], v4, s[24:27], s56 offen
    buffer_load_dwordx4 v[40:43], v4, s[48:51], s56 offen
    buffer_load_dwordx2 v[46:47], v5, s[40:43], s57 offen
    s_waitcnt vmcnt(0)
    v_lshlrev_b32 v44, 16, v46
    v_and_b32 v45, 0xffff0000, v46
    v_lshlrev_b32 v46, 16, v47
    v_and_b32 v47, 0xffff0000, v47
    v_cmp_eq_u32 s[74:75], s68, v36
K2_SLOW_M0:
    s_cmp_eq_u64 s[74:75], 0
    s_cbranch_scc1 K2_SLOW_X0
    s_ff1_i32_b64 s71, s[74:75]
    s_bitset0_b64 s[74:75], s71
    s_add_u32 s70, s70, 1
    v_readlane_b32 s72, v40, s71
    v_readlane_b32 s73, v44, s71
    s_nop 1
    v_mov_b32 v16, s72
    buffer_load_ushort v49, v[16:17], s[28:31], 0 idxen offen
    v_fma_f32 v2, s73, v32, v33
    s_waitcnt vmcnt(0)
    v_lshlrev_b32 v49, 16, v49
    v_add_f32 v49, v49, v2
    v_exp_f32 v2, v49
    s_nop 0
    v_add_f32 v2, 1.0, v2
    v_rcp_f32 v2, v2
    s_nop 0
    v_fma_f32 v34, v49, v2, v34
    s_branch K2_SLOW_M0
K2_SLOW_X0:
    v_cmp_eq_u32 s[74:75], s68, v37
K2_SLOW_M1:
    s_cmp_eq_u64 s[74:75], 0
    s_cbranch_scc1 K2_SLOW_X1
    s_ff1_i32_b64 s71, s[74:75]
    s_bitset0_b64 s[74:75], s71
    s_add_u32 s70, s70, 1
    v_readlane_b32 s72, v41, s71
    v_readlane_b32 s73, v45, s71
    s_nop 1
    v_mov_b32 v16, s72
    buffer_load_ushort v49, v[16:17], s[28:31], 0 idxen offen
    v_fma_f32 v2, s73, v32, v33
    s_waitcnt vmcnt(0)
    v_lshlrev_b32 v49, 16, v49
    v_add_f32 v49, v49, v2
    v_exp_f32 v2, v49
    s_nop 0
    v_add_f32 v2, 1.0, v2
    v_rcp_f32 v2, v2
    s_nop 0
    v_fma_f32 v34, v49, v2, v34
    s_branch K2_SLOW_M1
K2_SLOW_X1:
    v_cmp_eq_u32 s[74:75], s68, v38
K2_SLOW_M2:
    s_cmp_eq_u64 s[74:75], 0
    s_cbranch_scc1 K2_SLOW_X2
    s_ff1_i32_b64 s71, s[74:75]
    s_bitset0_b64 s[74:75], s71
    s_add_u32 s70, s70, 1
    v_readlane_b32 s72, v42, s71
    v_readlane_b32 s73, v46, s71
    s_nop 1
    v_mov_b32 v16, s72
    buffer_load_ushort v49, v[16:17], s[28:31], 0 idxen offen
    v_fma_f32 v2, s73, v32, v33
    s_waitcnt vmcnt(0)
    v_lshlrev_b32 v49, 16, v49
    v_add_f32 v49, v49, v2
    v_exp_f32 v2, v49
    s_nop 0
    v_add_f32 v2, 1.0, v2
    v_rcp_f32 v2, v2
    s_nop 0
    v_fma_f32 v34, v49, v2, v34
    s_branch K2_SLOW_M2
K2_SLOW_X2:
    v_cmp_eq_u32 s[74:75], s68, v39
K2_SLOW_M3:
    s_cmp_eq_u64 s[74:75], 0
    s_cbranch_scc1 K2_SLOW_X3
    s_ff1_i32_b64 s71, s[74:75]
    s_bitset0_b64 s[74:75], s71
    s_add_u32 s70, s70, 1
    v_readlane_b32 s72, v43, s71
    v_readlane_b32 s73, v47, s71
    s_nop 1
    v_mov_b32 v16, s72
    buffer_load_ushort v49, v[16:17], s[28:31], 0 idxen offen
    v_fma_f32 v2, s73, v32, v33
    s_waitcnt vmcnt(0)
    v_lshlrev_b32 v49, 16, v49
    v_add_f32 v49, v49, v2
    v_exp_f32 v2, v49
    s_nop 0
    v_add_f32 v2, 1.0, v2
    v_rcp_f32 v2, v2
    s_nop 0
    v_fma_f32 v34, v49, v2, v34
    s_branch K2_SLOW_M3
K2_SLOW_X3:
    s_add_u32 s69, s69, 256
    s_cmp_lt_u32 s69, 160000
    s_cbranch_scc1 K2_SLOW_C
    v_cvt_pk_bf16_f32 v34, v34, v34
    s_lshl_b32 s56, s58, 3
    v_mov_b32 v2, s56
    v_mov_b32 v3, s70
    ds_write_b32 v2, v3 offset:24580
    s_lshr_b32 s56, s58, 3
    s_lshl_b32 s56, s56, 13
    s_lshl_b32 s57, s53, 10
    s_add_u32 s56, s56, s57
    s_and_b32 s57, s58, 7
    s_lshl_b32 s57, s57, 6
    s_add_u32 s56, s56, s57
    s_and_b32 s57, s58, 4
    s_lshl_b32 s57, s57, 3
    v_xor_b32 v2, s57, v48
    buffer_store_short v34, v2, s[36:39], s56 offen sc1
    s_add_u32 s58, s58, 16
    s_waitcnt vmcnt(0) lgkmcnt(0)
    s_branch K2_SLOW_N
K2_SLOW_E:
    s_waitcnt vmcnt(0) lgkmcnt(0)
    s_barrier
    s_and_b32 s68, s52, 7
    s_lshr_b32 s69, s52, 3
    s_and_b32 s56, s53, 1
    s_lshr_b32 s70, s68, 2
    s_xor_b32 s70, s70, s56
    s_mov_b64 exec, 1
    ds_add_rtn_u32 v2, v126, v123 offset:80
    s_mov_b64 exec, -1
    s_waitcnt lgkmcnt(0)
    v_readfirstlane_b32 s71, v2
    s_mov_b32 s84, 1
    s_mov_b64 s[86:87], exec
    s_mov_b64 exec, 1
    s_lshl_b32 s56, s84, 2
    v_add_u32 v2, s56, v126
    ds_add_rtn_u32 v2, v2, v123 offset:64
    s_lshl_b32 s56, s84, 3
    s_add_u32 s56, s56, s53
    s_sub_u32 s56, s56, 8
    s_lshl_b32 s56, s56, 7
    v_mov_b32 v3, s56
    s_mov_b32 s84, 0
    s_waitcnt lgkmcnt(0)
    v_readfirstlane_b32 s56, v2
    s_cmp_lg_u32 s56, 960
    s_cbranch_scc1 K2_CES
    buffer_store_dword v123, v3, s[80:83], 0 offen sc1
K2_CES:
    s_mov_b64 exec, s[86:87]
    s_mov_b32 s84, 2
    s_branch K2_TAIL
K2_END:
    s_endpgm
.section .rodata,"a"
.p2align 6
.amdhsa_kernel k1_kernel
  .amdhsa_next_free_vgpr 235
  .amdhsa_next_free_sgpr 72
  .amdhsa_accum_offset 236
  .amdhsa_group_segment_fixed_size 0
  .amdhsa_kernarg_size 88
  .amdhsa_user_sgpr_count 2
  .amdhsa_user_sgpr_kernarg_segment_ptr 1
  .amdhsa_system_sgpr_workgroup_id_x 1
  .amdhsa_float_denorm_mode_32 3
.end_amdhsa_kernel
.p2align 6
.amdhsa_kernel k2_kernel
  .amdhsa_next_free_vgpr 127
  .amdhsa_next_free_sgpr 96
  .amdhsa_accum_offset 128
  .amdhsa_group_segment_fixed_size 0
  .amdhsa_kernarg_size 88
  .amdhsa_user_sgpr_count 2
  .amdhsa_user_sgpr_kernarg_segment_ptr 1
  .amdhsa_system_sgpr_workgroup_id_x 1
  .amdhsa_float_denorm_mode_32 3
.end_amdhsa_kernel
```
